```python
import torch

def _softmax(x, axis=-1):
    return torch.softmax(x, dim=axis)
def _gelu(x):
    return torch.nn.functional.gelu(x, approximate="tanh")
def _silu(x):
    return torch.nn.functional.silu(x)
def _sigmoid(x):
    return torch.sigmoid(x)
def _layernorm(x, axis=-1, eps=1e-5):
    m = x.mean(dim=axis, keepdim=True)
    v = x.var(dim=axis, keepdim=True, unbiased=False)
    return (x - m) / torch.sqrt(v + eps)
def _scatter_add(tgt, idx, src, axis=0):
    return tgt.clone().index_add_(axis, idx, src)
def _segment_sum(src, seg, n):
    out = torch.zeros((n,) + src.shape[1:], dtype=src.dtype)
    return out.index_add_(0, seg, src)
def _pad(x, pw):
    flat = tuple(v for pair in reversed(pw) for v in pair)
    return torch.nn.functional.pad(x, flat)

kernel_name = 'concat_heads__mha_block__linear_attn_block__prompt'

def setup_inputs():

    _w = (lambda a: (lambda t: t.to(torch.bfloat16) if t.is_floating_point() else t)(torch.as_tensor(a)))
    def _A_setup():
        B, S, D, H = 1, 2048, 576, 32
        return {
            "x": _w((lambda *s: torch.randn(*s, dtype=torch.bfloat16) * 0.2)(B, S, D)),
            "wqkv": _w((lambda *s: torch.randn(*s, dtype=torch.bfloat16) * 0.2)(D, 3 * D)),
            "wo": _w((lambda *s: torch.randn(*s, dtype=torch.bfloat16) * 0.05)(D, D)),
        }
    _A_in = _A_setup()

    def _B_setup():
        B, S, D = 1, 2048, 576
        return {
            "x": _w((lambda *s: torch.randn(*s, dtype=torch.bfloat16) * 0.05)(B, S, D)),
            "wqkv": _w((lambda *s: torch.randn(*s, dtype=torch.bfloat16) * 1.6)(D, 3 * D)),
            "wo": _w((lambda *s: torch.randn(*s, dtype=torch.bfloat16) * 0.05)(D, D)),
        }
    _B_in = _B_setup()

    return {
        "A_x": _A_in["x"],
        "A_wqkv": _A_in["wqkv"],
        "A_wo": _A_in["wo"],
        "B_x": _B_in["x"],
        "B_wqkv": _B_in["wqkv"],
        "B_wo": _B_in["wo"],
    }

def reference(A_x, A_wqkv, A_wo, B_x, B_wqkv, B_wo):
    def _A_ref(x, wqkv, wo):
        B, S, D = x.shape
        H = 32
        Dh = D // H
        qkv = (lambda x, *d: x.permute(*d))((x @ wqkv).reshape(B, S, 3, H, Dh), 2, 0, 3, 1, 4)
        q, k, v = qkv[0], qkv[1], qkv[2]
        scores = torch.einsum("bhqd,bhkd->bhqk", q, k) * (Dh ** -0.5)
        p = _softmax(scores, axis=-1)
        o = torch.einsum("bhqk,bhkd->bhqd", p, v)
        return (lambda x, *d: x.permute(*d))(o, 0, 2, 1, 3).reshape(B, S, D) @ wo

    def _B_ref(x, wqkv, wo):
        B, S, D = x.shape
        H = 32; Dh = D // H
        qkv = (lambda x, *d: x.permute(*d))((x @ wqkv).reshape(B, S, 3, H, Dh), 2, 0, 3, 1, 4)
        q, k, v = qkv[0], qkv[1], qkv[2]
        phi = lambda t: torch.where(t > 0, t + 1, torch.exp(t)) + 1e-6
        pq, pk = phi(q), phi(k)
        kv = torch.einsum("bhsd,bhse->bhde", pk, v)
        z = torch.einsum("bhsd->bhd", pk)
        num = torch.einsum("bhqd,bhde->bhqe", pq, kv)
        den = torch.einsum("bhqd,bhd->bhq", pq, z)[..., None] + 1e-6
        o = num / den
        return (lambda x, *d: x.permute(*d))(o, 0, 2, 1, 3).reshape(B, S, D) @ wo

    a = _A_ref(A_x, A_wqkv, A_wo)
    b = _B_ref(B_x, B_wqkv, B_wo)
    return torch.concatenate([a, b], axis=-1)
```

```asm
; @launch grid=(256,1,1) block=(512,1,1) lds=163840
.amdgcn_target "amdgcn-amd-amdhsa--gfx950"
.text
  .globl concat_heads__mha_block__linear_attn_block__prompt_kernel
  .p2align 8
  .type concat_heads__mha_block__linear_attn_block__prompt_kernel,@function
concat_heads__mha_block__linear_attn_block__prompt_kernel:
  s_cmp_ge_u32 s2, 256
  s_cbranch_scc1 L_END
  s_load_dwordx16 s[40:55], s[0:1], 0
  s_load_dwordx2 s[56:57], s[0:1], 64
  v_lshrrev_b32 v1, 6, v0
  v_mov_b32 v2, v0
  v_readfirstlane_b32 s3, v1
  v_and_b32 v0, 63, v0
  v_lshlrev_b32 v1, 4, v0
  v_and_b32 v3, 31, v0
  v_lshlrev_b32 v3, 2, v3
  v_lshrrev_b32 v4, 5, v0
  v_sub_u32 v4, 0, v4
  s_and_b32 s28, s2, 7
  s_lshr_b32 s29, s2, 3
  s_and_b32 s33, s29, 7
  s_lshr_b32 s31, s29, 3
  s_lshl_b32 s32, s28, 2
  s_add_u32 s32, s32, s31
  s_lshr_b32 s24, s28, 2
  s_and_b32 s30, s28, 1
  s_lshl_b32 s30, s30, 3
  s_add_u32 s25, s30, s33
  s_bfe_u32 s30, s28, 0x10001
  s_lshl_b32 s30, s30, 2
  s_add_u32 s26, s30, s31
  s_lshl_b32 s30, s31, 1
  s_add_u32 s27, s33, s30
  s_cmp_ge_u32 s3, 4
  s_cbranch_scc0 P1_COMPUTE
  s_sub_u32 s63, s3, 4
  s_setprio 1
  s_cmp_ge_u32 s27, 9
  s_cselect_b32 s28, 9, 0
  s_sub_u32 s62, s27, s28
  s_lshl_b32 s60, s62, 1
  v_lshrrev_b32 v12, 3, v0
  v_and_b32 v13, 7, v0
  v_bfe_u32 v14, v0, 4, 2
  s_and_b32 s28, s63, 1
  s_lshl_b32 s28, s28, 2
  v_or_b32 v14, s28, v14
  v_xor_b32 v13, v13, v14
  v_lshlrev_b32 v13, 4, v13
  v_mul_u32_u24 v12, 1152, v12
  v_add_u32 v5, v12, v13
  s_mul_i32 s34, s25, 147456
  s_mul_i32 s28, s63, 9216
  s_add_u32 s34, s34, s28
  s_lshl_b32 s28, s62, 7
  s_add_u32 s34, s34, s28
  s_lshl_b32 s36, s63, 10
  s_mov_b32 s61, 0
  s_mov_b32 s68, 16384
  s_mov_b32 s69, 4294934528
  s_mov_b32 s70, 14336
  s_mov_b32 s71, 4294909952
  s_lshl_b32 s28, s63, 6
  v_add_u32 v12, s28, v0
  v_mul_u32_u24 v13, 2341, v12
  v_lshrrev_b32 v13, 16, v13
  v_mul_u32_u24 v14, 28, v13
  v_sub_u32 v14, v12, v14
  v_min_u32 v14, 26, v14
  v_mul_u32_u24 v15, 57, v14
  v_lshrrev_b32 v15, 9, v15
  v_mul_u32_u24 v13, 3456, v13
  v_mul_u32_u24 v15, 1008, v15
  v_lshlrev_b32 v14, 4, v14
  v_add3_u32 v6, v13, v14, v15
  s_lshl_b32 s28, s63, 6
  s_add_u32 s28, s28, 256
  v_add_u32 v12, s28, v0
  v_mul_u32_u24 v13, 2341, v12
  v_lshrrev_b32 v13, 16, v13
  v_mul_u32_u24 v14, 28, v13
  v_sub_u32 v14, v12, v14
  v_min_u32 v14, 26, v14
  v_mul_u32_u24 v15, 57, v14
  v_lshrrev_b32 v15, 9, v15
  v_mul_u32_u24 v13, 3456, v13
  v_mul_u32_u24 v15, 1008, v15
  v_lshlrev_b32 v14, 4, v14
  v_add3_u32 v7, v13, v14, v15
  s_lshl_b32 s28, s63, 6
  s_add_u32 s28, s28, 512
  v_add_u32 v12, s28, v0
  v_mul_u32_u24 v13, 2341, v12
  v_lshrrev_b32 v13, 16, v13
  v_mul_u32_u24 v14, 28, v13
  v_sub_u32 v14, v12, v14
  v_min_u32 v14, 26, v14
  v_mul_u32_u24 v15, 57, v14
  v_lshrrev_b32 v15, 9, v15
  v_mul_u32_u24 v13, 3456, v13
  v_mul_u32_u24 v15, 1008, v15
  v_lshlrev_b32 v14, 4, v14
  v_add3_u32 v8, v13, v14, v15
  s_lshl_b32 s28, s63, 5
  s_add_u32 s28, s28, 768
  v_add_u32 v12, s28, v0
  v_mul_u32_u24 v13, 2341, v12
  v_lshrrev_b32 v13, 16, v13
  v_mul_u32_u24 v14, 28, v13
  v_sub_u32 v14, v12, v14
  v_min_u32 v14, 26, v14
  v_mul_u32_u24 v15, 57, v14
  v_lshrrev_b32 v15, 9, v15
  v_mul_u32_u24 v13, 3456, v13
  v_mul_u32_u24 v15, 1008, v15
  v_lshlrev_b32 v14, 4, v14
  v_add3_u32 v9, v13, v14, v15
  s_mul_i32 s35, s26, 144
  s_mul_i32 s28, s60, 110592
  s_add_u32 s35, s35, s28
  s_lshl_b32 s37, s63, 10
  s_add_u32 s37, s37, 49152
  s_lshl_b32 s28, s63, 9
  s_sub_u32 s59, 12288, s28
  s_mov_b32 s38, 0
  s_waitcnt lgkmcnt(0)
  s_cmp_eq_u32 s24, 0
  s_cselect_b32 s4, s40, s46
  s_cselect_b32 s5, s41, s47
  s_cselect_b32 s6, s42, s48
  s_cselect_b32 s7, s43, s49
  s_mov_b32 s12, s4
  s_mov_b32 s13, s5
  s_mov_b32 s14, 0x240000
  s_mov_b32 s15, 0x20000
  s_mov_b32 s16, s6
  s_mov_b32 s17, s7
  s_mov_b32 s18, 0x1e6000
  s_mov_b32 s19, 0x20000
  s_add_u32 m0, s36, 0
  s_add_u32 s28, s34, 0
  buffer_load_dwordx4 v5, s[12:15], s28 offen lds
  s_add_u32 m0, s36, 4096
  s_add_u32 s28, s34, 36864
  buffer_load_dwordx4 v5, s[12:15], s28 offen lds
  s_add_u32 m0, s36, 8192
  s_add_u32 s28, s34, 73728
  buffer_load_dwordx4 v5, s[12:15], s28 offen lds
  s_add_u32 m0, s36, 12288
  s_add_u32 s28, s34, 110592
  buffer_load_dwordx4 v5, s[12:15], s28 offen lds
  s_add_u32 s61, s61, 1
  s_cmp_eq_u32 s61, 3
  s_cselect_b32 s28, s69, s68
  s_cselect_b32 s61, 0, s61
  s_add_u32 s36, s36, s28
  s_add_u32 s34, s34, 128
  s_add_u32 s62, s62, 1
  s_cmp_eq_u32 s62, 9
  s_cselect_b32 s28, 1152, 0
  s_cselect_b32 s62, 0, s62
  s_sub_u32 s34, s34, s28
  s_mov_b32 m0, s37
  s_add_u32 s38, s38, 1
  buffer_load_dwordx4 v6, s[16:19], s35 offen lds
  s_add_u32 m0, s37, 4096
  s_nop 0
  buffer_load_dwordx4 v7, s[16:19], s35 offen lds
  s_add_u32 m0, s37, 8192
  s_cmp_eq_u32 s38, 5
  buffer_load_dwordx4 v8, s[16:19], s35 offen lds
  s_cselect_b32 s29, s71, s70
  s_cselect_b32 s38, 0, s38
  s_add_u32 m0, s37, s59
  s_mov_b32 exec_hi, 0
  buffer_load_dwordx4 v9, s[16:19], s35 offen lds
  s_mov_b32 exec_hi, -1
  s_add_u32 s37, s37, s29
  s_add_u32 s35, s35, 110592
  s_add_u32 s60, s60, 1
  s_cmp_eq_u32 s60, 18
  s_cselect_b32 s29, 1990656, 0
  s_cselect_b32 s60, 0, s60
  s_sub_u32 s35, s35, s29
  s_mov_b32 m0, s37
  s_add_u32 s38, s38, 1
  buffer_load_dwordx4 v6, s[16:19], s35 offen lds
  s_add_u32 m0, s37, 4096
  s_nop 0
  buffer_load_dwordx4 v7, s[16:19], s35 offen lds
  s_add_u32 m0, s37, 8192
  s_cmp_eq_u32 s38, 5
  buffer_load_dwordx4 v8, s[16:19], s35 offen lds
  s_cselect_b32 s29, s71, s70
  s_cselect_b32 s38, 0, s38
  s_add_u32 m0, s37, s59
  s_mov_b32 exec_hi, 0
  buffer_load_dwordx4 v9, s[16:19], s35 offen lds
  s_mov_b32 exec_hi, -1
  s_add_u32 s37, s37, s29
  s_add_u32 s35, s35, 110592
  s_add_u32 s60, s60, 1
  s_cmp_eq_u32 s60, 18
  s_cselect_b32 s29, 1990656, 0
  s_cselect_b32 s60, 0, s60
  s_sub_u32 s35, s35, s29
  s_add_u32 m0, s36, 0
  s_add_u32 s28, s34, 0
  buffer_load_dwordx4 v5, s[12:15], s28 offen lds
  s_add_u32 m0, s36, 4096
  s_add_u32 s28, s34, 36864
  buffer_load_dwordx4 v5, s[12:15], s28 offen lds
  s_mov_b32 s8, s56
  s_mov_b32 s9, s57
  s_mov_b32 s10, 0x2000000
  s_mov_b32 s11, 0x20000
  s_mov_b32 s20, s54
  s_mov_b32 s21, s55
  s_mov_b32 s22, 0x100
  s_mov_b32 s23, 0x20000
  s_mov_b32 s58, 0
  s_waitcnt vmcnt(6)
  s_barrier
P1_LLOOP:
  s_mov_b32 m0, s37
  s_add_u32 s38, s38, 1
  buffer_load_dwordx4 v6, s[16:19], s35 offen lds
  s_add_u32 m0, s37, 4096
  s_nop 0
  buffer_load_dwordx4 v7, s[16:19], s35 offen lds
  s_add_u32 m0, s37, 8192
  s_cmp_eq_u32 s38, 5
  buffer_load_dwordx4 v8, s[16:19], s35 offen lds
  s_cselect_b32 s29, s71, s70
  s_cselect_b32 s38, 0, s38
  s_add_u32 m0, s37, s59
  s_mov_b32 exec_hi, 0
  buffer_load_dwordx4 v9, s[16:19], s35 offen lds
  s_mov_b32 exec_hi, -1
  s_add_u32 s37, s37, s29
  s_add_u32 s35, s35, 110592
  s_add_u32 s60, s60, 1
  s_cmp_eq_u32 s60, 18
  s_cselect_b32 s29, 1990656, 0
  s_cselect_b32 s60, 0, s60
  s_sub_u32 s35, s35, s29
  s_add_u32 m0, s36, 8192
  s_add_u32 s28, s34, 73728
  buffer_load_dwordx4 v5, s[12:15], s28 offen lds
  s_add_u32 m0, s36, 12288
  s_add_u32 s28, s34, 110592
  buffer_load_dwordx4 v5, s[12:15], s28 offen lds
  s_add_u32 s61, s61, 1
  s_cmp_eq_u32 s61, 3
  s_cselect_b32 s28, s69, s68
  s_cselect_b32 s61, 0, s61
  s_add_u32 s36, s36, s28
  s_add_u32 s34, s34, 128
  s_add_u32 s62, s62, 1
  s_cmp_eq_u32 s62, 9
  s_cselect_b32 s28, 1152, 0
  s_cselect_b32 s62, 0, s62
  s_sub_u32 s34, s34, s28
  s_waitcnt vmcnt(6)
  s_barrier
  s_mov_b32 m0, s37
  s_add_u32 s38, s38, 1
  buffer_load_dwordx4 v6, s[16:19], s35 offen lds
  s_add_u32 m0, s37, 4096
  s_nop 0
  buffer_load_dwordx4 v7, s[16:19], s35 offen lds
  s_add_u32 m0, s37, 8192
  s_cmp_eq_u32 s38, 5
  buffer_load_dwordx4 v8, s[16:19], s35 offen lds
  s_cselect_b32 s29, s71, s70
  s_cselect_b32 s38, 0, s38
  s_add_u32 m0, s37, s59
  s_mov_b32 exec_hi, 0
  buffer_load_dwordx4 v9, s[16:19], s35 offen lds
  s_mov_b32 exec_hi, -1
  s_add_u32 s37, s37, s29
  s_add_u32 s35, s35, 110592
  s_add_u32 s60, s60, 1
  s_cmp_eq_u32 s60, 18
  s_cselect_b32 s29, 1990656, 0
  s_cselect_b32 s60, 0, s60
  s_sub_u32 s35, s35, s29
  s_add_u32 m0, s36, 0
  s_add_u32 s28, s34, 0
  buffer_load_dwordx4 v5, s[12:15], s28 offen lds
  s_add_u32 m0, s36, 4096
  s_add_u32 s28, s34, 36864
  buffer_load_dwordx4 v5, s[12:15], s28 offen lds
  s_waitcnt vmcnt(6)
  s_barrier
  s_add_u32 s58, s58, 1
  s_cmp_lt_u32 s58, 7
  s_cbranch_scc1 P1_LLOOP
  s_mov_b32 m0, s37
  s_add_u32 s38, s38, 1
  buffer_load_dwordx4 v6, s[16:19], s35 offen lds
  s_add_u32 m0, s37, 4096
  s_nop 0
  buffer_load_dwordx4 v7, s[16:19], s35 offen lds
  s_add_u32 m0, s37, 8192
  s_cmp_eq_u32 s38, 5
  buffer_load_dwordx4 v8, s[16:19], s35 offen lds
  s_cselect_b32 s29, s71, s70
  s_cselect_b32 s38, 0, s38
  s_add_u32 m0, s37, s59
  s_mov_b32 exec_hi, 0
  buffer_load_dwordx4 v9, s[16:19], s35 offen lds
  s_mov_b32 exec_hi, -1
  s_add_u32 s37, s37, s29
  s_add_u32 s35, s35, 110592
  s_add_u32 s60, s60, 1
  s_cmp_eq_u32 s60, 18
  s_cselect_b32 s29, 1990656, 0
  s_cselect_b32 s60, 0, s60
  s_sub_u32 s35, s35, s29
  s_add_u32 m0, s36, 8192
  s_add_u32 s28, s34, 73728
  buffer_load_dwordx4 v5, s[12:15], s28 offen lds
  s_add_u32 m0, s36, 12288
  s_add_u32 s28, s34, 110592
  buffer_load_dwordx4 v5, s[12:15], s28 offen lds
  s_add_u32 s61, s61, 1
  s_cmp_eq_u32 s61, 3
  s_cselect_b32 s28, s69, s68
  s_cselect_b32 s61, 0, s61
  s_add_u32 s36, s36, s28
  s_add_u32 s34, s34, 128
  s_add_u32 s62, s62, 1
  s_cmp_eq_u32 s62, 9
  s_cselect_b32 s28, 1152, 0
  s_cselect_b32 s62, 0, s62
  s_sub_u32 s34, s34, s28
  s_waitcnt vmcnt(6)
  s_barrier
  s_mov_b32 m0, s37
  s_add_u32 s38, s38, 1
  buffer_load_dwordx4 v6, s[16:19], s35 offen lds
  s_add_u32 m0, s37, 4096
  s_nop 0
  buffer_load_dwordx4 v7, s[16:19], s35 offen lds
  s_add_u32 m0, s37, 8192
  s_cmp_eq_u32 s38, 5
  buffer_load_dwordx4 v8, s[16:19], s35 offen lds
  s_cselect_b32 s29, s71, s70
  s_cselect_b32 s38, 0, s38
  s_add_u32 m0, s37, s59
  s_mov_b32 exec_hi, 0
  buffer_load_dwordx4 v9, s[16:19], s35 offen lds
  s_mov_b32 exec_hi, -1
  s_add_u32 s37, s37, s29
  s_add_u32 s35, s35, 110592
  s_add_u32 s60, s60, 1
  s_cmp_eq_u32 s60, 18
  s_cselect_b32 s29, 1990656, 0
  s_cselect_b32 s60, 0, s60
  s_sub_u32 s35, s35, s29
  s_waitcnt vmcnt(4)
  s_barrier
  s_waitcnt vmcnt(0)
  s_barrier
  v_and_b32 v12, 3, v0
  v_lshlrev_b32 v12, 6, v12
  s_mov_b32 s31, 200000
P1_CL:
  buffer_load_dword v13, v12, s[20:23], 0 offen sc1
  s_waitcnt vmcnt(0)
  v_cmp_gt_u32 vcc, 64, v13
  s_nop 3
  s_cmp_eq_u64 vcc, 0
  s_cbranch_scc1 P1_CD
  s_sub_u32 s31, s31, 1
  s_cmp_lg_u32 s31, 0
  s_cbranch_scc1 P1_CL
P1_CD:
  s_barrier
  s_cmp_eq_u32 s24, 0
  s_cbranch_scc0 P1_LNOV
  s_mul_i32 s30, s63, 4864
  s_add_u32 s30, s30, 140288
  v_add_u32 v12, s30, v1
  ds_read_b128 v[16:19], v12 offset:0
  ds_read_b128 v[20:23], v12 offset:1024
  ds_read_b128 v[24:27], v12 offset:2048
  ds_read_b128 v[28:31], v12 offset:3072
  ds_read_b128 v[32:35], v12 offset:4096
  s_lshl_b32 s28, s26, 2
  s_add_u32 s28, s28, s63
  s_mul_i32 s28, s28, 151552
  s_lshr_b32 s29, s25, 2
  s_mul_i32 s29, s29, 37888
  s_add_u32 s28, s28, s29
  s_and_b32 s29, s25, 3
  s_mul_i32 s29, s29, 4864
  s_add_u32 s28, s28, s29
  s_add_u32 s28, s28, 18432
  s_add_u32 s29, s28, 4096
  v_cmp_gt_u32 vcc, 48, v0
  v_mov_b32 v13, 2147483648
  s_nop 0
  v_cndmask_b32 v13, v13, v1, vcc
  s_waitcnt lgkmcnt(4)
  buffer_store_dwordx4 v[16:19], v1, s[8:11], s28 offen offset:0 sc1
  s_waitcnt lgkmcnt(3)
  buffer_store_dwordx4 v[20:23], v1, s[8:11], s28 offen offset:1024 sc1
  s_waitcnt lgkmcnt(2)
  buffer_store_dwordx4 v[24:27], v1, s[8:11], s28 offen offset:2048 sc1
  s_waitcnt lgkmcnt(1)
  buffer_store_dwordx4 v[28:31], v1, s[8:11], s28 offen offset:3072 sc1
  s_waitcnt lgkmcnt(0)
  buffer_store_dwordx4 v[32:35], v13, s[8:11], s29 offen sc1
  s_waitcnt vmcnt(0)
  s_mov_b64 exec, 1
  v_mov_b32 v12, 163328
  v_mov_b32 v13, 1
  ds_add_rtn_u32 v14, v12, v13
  s_waitcnt lgkmcnt(0)
  v_readfirstlane_b32 s28, v14
  s_nop 3
  s_cmp_eq_u32 s28, 7
  s_cbranch_scc0 P1_LS_N
  s_lshl_b32 s28, s24, 14
  s_lshl_b32 s29, s26, 11
  s_add_u32 s28, s28, s29
  s_lshl_b32 s29, s25, 7
  s_add_u32 s28, s28, s29
  s_add_u32 s28, s28, 17825792
  v_mov_b32 v12, 0
  buffer_store_dword v13, v12, s[8:11], s28 offen sc1
P1_LS_N:
  s_mov_b64 exec, -1
P1_LNOV:
  s_cmp_eq_u32 s63, 0
  s_cbranch_scc0 P1_PW
  v_and_b32 v13, 15, v0
  v_lshlrev_b32 v13, 7, v13
  s_and_b32 s28, s2, 7
  s_lshl_b32 s28, s28, 11
  s_add_u32 s28, s28, 17825792
  s_waitcnt vmcnt(0)
  s_mov_b32 s31, 200000
P1_PF_L:
  buffer_load_dword v12, v13, s[8:11], s28 offen sc1
  s_waitcnt vmcnt(0)
  v_cmp_ne_u32 vcc, 1, v12
  s_nop 3
  s_cmp_eq_u64 vcc, 0
  s_cbranch_scc1 P1_PF_D
  s_sub_u32 s31, s31, 1
  s_cmp_lg_u32 s31, 0
  s_cbranch_scc1 P1_PF_L
P1_PF_D:
  s_waitcnt vmcnt(0)
  v_mov_b32 v12, 163332
  v_mov_b32 v14, 1
  ds_write_b32 v12, v14
  s_branch P1_PD
P1_PW:
  s_mov_b32 s31, 1600000
  v_mov_b32 v12, 163332
P1_PL_L:
  ds_read_b32 v14, v12
  s_waitcnt lgkmcnt(0)
  v_readfirstlane_b32 s4, v14
  s_nop 3
  s_cmp_eq_u32 s4, 1
  s_cbranch_scc1 P1_PL_D
  s_sub_u32 s31, s31, 1
  s_cmp_lg_u32 s31, 0
  s_cbranch_scc1 P1_PL_L
P1_PL_D:
P1_PD:
  s_mul_i32 s34, s32, 151552
  s_add_u32 s34, s34, 0
  s_lshl_b32 s28, s32, 6
  s_lshl_b32 s29, s33, 3
  s_add_u32 s28, s28, s29
  s_mul_i32 s35, s28, 1152
  s_add_u32 s35, s35, 5204992
  s_mov_b32 s36, s63
P1_KVL:
  s_min_u32 s37, s36, 45
  s_lshl_b32 s38, s37, 10
  s_cmp_ge_u32 s37, 37
  s_cselect_b32 s39, s35, s34
  s_cselect_b32 s37, 37888, 0
  s_add_u32 m0, s37, s38
  s_add_u32 s39, s39, s38
  buffer_load_dwordx4 v1, s[8:11], s39 offen sc1 lds
  s_add_u32 s36, s36, 4
  s_cmp_lt_u32 s36, 48
  s_cbranch_scc1 P1_KVL
  s_setprio 0
  s_branch P2_SETUP
P1_COMPUTE:
  v_and_b32 v12, 31, v0
  v_lshrrev_b32 v13, 5, v0
  v_bfe_u32 v14, v0, 1, 3
  v_xor_b32 v14, v13, v14
  v_lshlrev_b32 v14, 4, v14
  v_lshlrev_b32 v12, 7, v12
  s_lshl_b32 s28, s3, 12
  v_add3_u32 v6, v12, v14, s28
  v_xor_b32 v7, 32, v6
  v_xor_b32 v8, 64, v6
  v_xor_b32 v9, 0x60, v6
  v_lshlrev_b32 v13, 3, v13
  v_bfe_u32 v14, v0, 2, 2
  v_add_u32 v13, v13, v14
  v_mul_u32_u24 v13, 448, v13
  v_bfe_u32 v14, v0, 4, 1
  v_lshlrev_b32 v14, 5, v14
  v_and_b32 v15, 3, v0
  v_lshlrev_b32 v15, 3, v15
  v_add3_u32 v10, v13, v14, v15
  v_add_u32 v10, 49152, v10
  s_waitcnt lgkmcnt(0)
  s_mov_b32 s8, s56
  s_mov_b32 s9, s57
  s_mov_b32 s10, 0x2000000
  s_mov_b32 s11, 0x20000
  s_mov_b32 s20, s54
  s_mov_b32 s21, s55
  s_mov_b32 s22, 0x100
  s_mov_b32 s23, 0x20000
  s_cmp_eq_u32 s3, 0
  s_cbranch_scc0 P1_NOCLR
  s_lshl_b32 s28, s24, 14
  s_lshl_b32 s29, s26, 11
  s_add_u32 s28, s28, s29
  s_lshl_b32 s29, s25, 7
  s_add_u32 s28, s28, s29
  s_add_u32 s28, s28, 17825792
  s_lshl_b32 s30, s33, 12
  s_lshl_b32 s29, s32, 7
  s_add_u32 s30, s30, s29
  s_add_u32 s30, s30, 17858560
  s_mov_b64 exec, 1
  v_mov_b32 v16, 0
  v_mov_b32 v18, 163328
  buffer_store_dword v16, v16, s[8:11], s28 offen sc1
  buffer_store_dword v16, v16, s[8:11], s30 offen sc1
  ds_write_b32 v18, v16
  ds_write_b32 v18, v16 offset:4
  ds_write_b32 v18, v16 offset:8
  s_mov_b64 exec, -1
P1_NOCLR:
  v_mov_b32 v92, 0
  v_mov_b32 v93, 0
  v_mov_b32 v94, 0
  v_mov_b32 v95, 0
  s_mov_b32 s68, 16384
  s_mov_b32 s69, 4294934528
  s_mov_b32 s70, 14336
  s_mov_b32 s71, 4294909952
  v_mfma_f32_32x32x16_bf16 v[128:143], v[92:95], v[92:95], 0
  v_mfma_f32_32x32x16_bf16 v[144:159], v[92:95], v[92:95], 0
  v_mfma_f32_32x32x16_bf16 v[160:175], v[92:95], v[92:95], 0
  v_mfma_f32_32x32x16_bf16 v[176:191], v[92:95], v[92:95], 0
  v_mfma_f32_32x32x16_bf16 v[192:207], v[92:95], v[92:95], 0
  v_mfma_f32_32x32x16_bf16 v[208:223], v[92:95], v[92:95], 0
  v_mfma_f32_32x32x16_bf16 v[224:239], v[92:95], v[92:95], 0
  s_mov_b32 s39, 0
  s_mov_b32 s61, 0
  s_mov_b32 s58, 0
  s_cmp_eq_u32 s3, 0
  s_cbranch_scc0 P1_NOCNT
  s_mov_b64 exec, 1
  v_mov_b32 v16, 0
  v_mov_b32 v17, 1
  s_and_b32 s28, s2, 3
  s_lshl_b32 s28, s28, 6
  s_waitcnt vmcnt(0) lgkmcnt(0)
  buffer_atomic_add v17, v16, s[20:23], s28 offen sc1
  s_mov_b64 exec, -1
P1_NOCNT:
  s_barrier
  ds_read_b128 v[92:95], v6
  ds_read_b64_tr_b16 v[64:65], v10 offset:0
  ds_read_b64_tr_b16 v[66:67], v10 offset:1792
  ds_read_b64_tr_b16 v[68:69], v10 offset:64
  ds_read_b64_tr_b16 v[70:71], v10 offset:1856
  ds_read_b64_tr_b16 v[72:73], v10 offset:128
  ds_read_b64_tr_b16 v[74:75], v10 offset:1920
  ds_read_b64_tr_b16 v[76:77], v10 offset:192
  ds_read_b64_tr_b16 v[78:79], v10 offset:1984
  ds_read_b64_tr_b16 v[80:81], v10 offset:256
  ds_read_b64_tr_b16 v[82:83], v10 offset:2048
  .p2align 6
P1_LOOP:
  s_waitcnt lgkmcnt(8)
  v_mfma_f32_32x32x16_bf16 v[128:143], v[64:67], v[92:95], v[128:143]
  ds_read_b64_tr_b16 v[84:85], v10 offset:320
  ds_read_b64_tr_b16 v[86:87], v10 offset:2112
  s_waitcnt lgkmcnt(8)
  v_mfma_f32_32x32x16_bf16 v[144:159], v[68:71], v[92:95], v[144:159]
  ds_read_b128 v[96:99], v7
  ds_read_b64_tr_b16 v[88:89], v10 offset:384
  ds_read_b64_tr_b16 v[90:91], v10 offset:2176
  s_waitcnt lgkmcnt(9)
  v_mfma_f32_32x32x16_bf16 v[160:175], v[72:75], v[92:95], v[160:175]
  ds_read_b64_tr_b16 v[64:65], v10 offset:7168
  ds_read_b64_tr_b16 v[66:67], v10 offset:8960
  s_waitcnt lgkmcnt(9)
  v_mfma_f32_32x32x16_bf16 v[176:191], v[76:79], v[92:95], v[176:191]
  ds_read_b64_tr_b16 v[68:69], v10 offset:7232
  ds_read_b64_tr_b16 v[70:71], v10 offset:9024
  s_waitcnt lgkmcnt(9)
  v_mfma_f32_32x32x16_bf16 v[192:207], v[80:83], v[92:95], v[192:207]
  ds_read_b64_tr_b16 v[72:73], v10 offset:7296
  ds_read_b64_tr_b16 v[74:75], v10 offset:9088
  s_waitcnt lgkmcnt(9)
  v_mfma_f32_32x32x16_bf16 v[208:223], v[84:87], v[92:95], v[208:223]
  ds_read_b64_tr_b16 v[76:77], v10 offset:7360
  ds_read_b64_tr_b16 v[78:79], v10 offset:9152
  s_waitcnt lgkmcnt(8)
  v_mfma_f32_32x32x16_bf16 v[224:239], v[88:91], v[92:95], v[224:239]
  ds_read_b64_tr_b16 v[80:81], v10 offset:7424
  ds_read_b64_tr_b16 v[82:83], v10 offset:9216
  s_waitcnt lgkmcnt(8)
  v_mfma_f32_32x32x16_bf16 v[128:143], v[64:67], v[96:99], v[128:143]
  ds_read_b64_tr_b16 v[84:85], v10 offset:7488
  ds_read_b64_tr_b16 v[86:87], v10 offset:9280
  s_waitcnt lgkmcnt(8)
  v_mfma_f32_32x32x16_bf16 v[144:159], v[68:71], v[96:99], v[144:159]
  ds_read_b64_tr_b16 v[88:89], v10 offset:7552
  ds_read_b64_tr_b16 v[90:91], v10 offset:9344
  s_waitcnt lgkmcnt(8)
  v_mfma_f32_32x32x16_bf16 v[160:175], v[72:75], v[96:99], v[160:175]
  s_add_u32 s39, s39, 1
  s_cmp_eq_u32 s39, 5
  s_cselect_b32 s31, s71, s70
  s_cselect_b32 s39, 0, s39
  v_add_u32 v10, s31, v10
  s_barrier
  ds_read_b128 v[92:95], v8
  ds_read_b64_tr_b16 v[64:65], v10 offset:0
  ds_read_b64_tr_b16 v[66:67], v10 offset:1792
  s_waitcnt lgkmcnt(9)
  v_mfma_f32_32x32x16_bf16 v[176:191], v[76:79], v[96:99], v[176:191]
  ds_read_b64_tr_b16 v[68:69], v10 offset:64
  ds_read_b64_tr_b16 v[70:71], v10 offset:1856
  s_waitcnt lgkmcnt(9)
  v_mfma_f32_32x32x16_bf16 v[192:207], v[80:83], v[96:99], v[192:207]
  ds_read_b64_tr_b16 v[72:73], v10 offset:128
  ds_read_b64_tr_b16 v[74:75], v10 offset:1920
  s_waitcnt lgkmcnt(9)
  v_mfma_f32_32x32x16_bf16 v[208:223], v[84:87], v[96:99], v[208:223]
  ds_read_b64_tr_b16 v[76:77], v10 offset:192
  ds_read_b64_tr_b16 v[78:79], v10 offset:1984
  s_waitcnt lgkmcnt(9)
  v_mfma_f32_32x32x16_bf16 v[224:239], v[88:91], v[96:99], v[224:239]
  ds_read_b64_tr_b16 v[80:81], v10 offset:256
  ds_read_b64_tr_b16 v[82:83], v10 offset:2048
  s_waitcnt lgkmcnt(8)
  v_mfma_f32_32x32x16_bf16 v[128:143], v[64:67], v[92:95], v[128:143]
  ds_read_b64_tr_b16 v[84:85], v10 offset:320
  ds_read_b64_tr_b16 v[86:87], v10 offset:2112
  s_waitcnt lgkmcnt(8)
  v_mfma_f32_32x32x16_bf16 v[144:159], v[68:71], v[92:95], v[144:159]
  ds_read_b128 v[96:99], v9
  ds_read_b64_tr_b16 v[88:89], v10 offset:384
  ds_read_b64_tr_b16 v[90:91], v10 offset:2176
  s_waitcnt lgkmcnt(9)
  v_mfma_f32_32x32x16_bf16 v[160:175], v[72:75], v[92:95], v[160:175]
  ds_read_b64_tr_b16 v[64:65], v10 offset:7168
  ds_read_b64_tr_b16 v[66:67], v10 offset:8960
  s_waitcnt lgkmcnt(9)
  v_mfma_f32_32x32x16_bf16 v[176:191], v[76:79], v[92:95], v[176:191]
  ds_read_b64_tr_b16 v[68:69], v10 offset:7232
  ds_read_b64_tr_b16 v[70:71], v10 offset:9024
  s_waitcnt lgkmcnt(9)
  v_mfma_f32_32x32x16_bf16 v[192:207], v[80:83], v[92:95], v[192:207]
  ds_read_b64_tr_b16 v[72:73], v10 offset:7296
  ds_read_b64_tr_b16 v[74:75], v10 offset:9088
  s_waitcnt lgkmcnt(9)
  v_mfma_f32_32x32x16_bf16 v[208:223], v[84:87], v[92:95], v[208:223]
  ds_read_b64_tr_b16 v[76:77], v10 offset:7360
  ds_read_b64_tr_b16 v[78:79], v10 offset:9152
  s_waitcnt lgkmcnt(8)
  v_mfma_f32_32x32x16_bf16 v[224:239], v[88:91], v[92:95], v[224:239]
  ds_read_b64_tr_b16 v[80:81], v10 offset:7424
  ds_read_b64_tr_b16 v[82:83], v10 offset:9216
  s_waitcnt lgkmcnt(8)
  v_mfma_f32_32x32x16_bf16 v[128:143], v[64:67], v[96:99], v[128:143]
  ds_read_b64_tr_b16 v[84:85], v10 offset:7488
  ds_read_b64_tr_b16 v[86:87], v10 offset:9280
  s_waitcnt lgkmcnt(8)
  v_mfma_f32_32x32x16_bf16 v[144:159], v[68:71], v[96:99], v[144:159]
  ds_read_b64_tr_b16 v[88:89], v10 offset:7552
  ds_read_b64_tr_b16 v[90:91], v10 offset:9344
  s_waitcnt lgkmcnt(8)
  v_mfma_f32_32x32x16_bf16 v[160:175], v[72:75], v[96:99], v[160:175]
  s_add_u32 s39, s39, 1
  s_cmp_eq_u32 s39, 5
  s_cselect_b32 s31, s71, s70
  s_cselect_b32 s39, 0, s39
  v_add_u32 v10, s31, v10
  s_add_u32 s61, s61, 1
  s_cmp_eq_u32 s61, 3
  s_cselect_b32 s30, s69, s68
  s_cselect_b32 s61, 0, s61
  v_add_u32 v6, s30, v6
  v_add_u32 v7, s30, v7
  v_add_u32 v8, s30, v8
  v_add_u32 v9, s30, v9
  s_cmp_eq_u32 s58, 8
  s_cbranch_scc1 P1_NOBAR
  s_barrier
P1_NOBAR:
  ds_read_b128 v[92:95], v6
  ds_read_b64_tr_b16 v[64:65], v10 offset:0
  ds_read_b64_tr_b16 v[66:67], v10 offset:1792
  s_waitcnt lgkmcnt(9)
  v_mfma_f32_32x32x16_bf16 v[176:191], v[76:79], v[96:99], v[176:191]
  ds_read_b64_tr_b16 v[68:69], v10 offset:64
  ds_read_b64_tr_b16 v[70:71], v10 offset:1856
  s_waitcnt lgkmcnt(9)
  v_mfma_f32_32x32x16_bf16 v[192:207], v[80:83], v[96:99], v[192:207]
  ds_read_b64_tr_b16 v[72:73], v10 offset:128
  ds_read_b64_tr_b16 v[74:75], v10 offset:1920
  s_waitcnt lgkmcnt(9)
  v_mfma_f32_32x32x16_bf16 v[208:223], v[84:87], v[96:99], v[208:223]
  ds_read_b64_tr_b16 v[76:77], v10 offset:192
  ds_read_b64_tr_b16 v[78:79], v10 offset:1984
  s_waitcnt lgkmcnt(9)
  v_mfma_f32_32x32x16_bf16 v[224:239], v[88:91], v[96:99], v[224:239]
  ds_read_b64_tr_b16 v[80:81], v10 offset:256
  ds_read_b64_tr_b16 v[82:83], v10 offset:2048
  s_add_u32 s58, s58, 1
  s_cmp_lt_u32 s58, 9
  s_cbranch_scc1 P1_LOOP
  s_waitcnt lgkmcnt(0)
  s_waitcnt vmcnt(0)
  s_nop 7
  s_cmp_eq_u32 s24, 0
  s_cbranch_scc0 P1_EPI_B
  s_mov_b32 s64, 0x3eae1a93
  s_mov_b32 s65, 0x3eae1a93
  v_cvt_pk_bf16_f32 v64, v164, v165
  v_cvt_pk_bf16_f32 v65, v166, v167
  v_cvt_pk_bf16_f32 v66, v168, v169
  v_cvt_pk_bf16_f32 v67, v170, v171
  v_cvt_pk_bf16_f32 v80, v172, v173
  v_cvt_pk_bf16_f32 v81, v174, v175
  v_cvt_pk_bf16_f32 v68, v176, v177
  v_cvt_pk_bf16_f32 v69, v178, v179
  v_cvt_pk_bf16_f32 v82, v180, v181
  v_cvt_pk_bf16_f32 v83, v182, v183
  v_cvt_pk_bf16_f32 v72, v184, v185
  v_cvt_pk_bf16_f32 v73, v186, v187
  v_cvt_pk_bf16_f32 v84, v188, v189
  v_cvt_pk_bf16_f32 v85, v190, v191
  v_cvt_pk_bf16_f32 v76, v192, v193
  v_cvt_pk_bf16_f32 v77, v194, v195
  v_cvt_pk_bf16_f32 v78, v196, v197
  v_cvt_pk_bf16_f32 v79, v198, v199
  v_bfi_b32 v70, v4, v80, v82
  v_bfi_b32 v74, v4, v82, v84
  v_bfi_b32 v71, v4, v81, v83
  v_bfi_b32 v75, v4, v83, v85
  v_bfi_b32 v86, v4, v84, v80
  v_bfi_b32 v87, v4, v85, v81
  v_and_b32 v13, 303104, v4
  v_add_u32 v13, v13, v3
  s_mul_i32 s28, s26, 606208
  s_add_u32 s28, s28, 0
  s_lshr_b32 s29, s25, 2
  s_mul_i32 s29, s29, 37888
  s_add_u32 s31, s28, s29
  s_and_b32 s29, s25, 3
  s_lshl_b32 s29, s29, 2
  s_add_u32 s29, s29, s3
  s_lshl_b32 s30, s29, 10
  s_add_u32 s28, s31, s30
  s_lshl_b32 s30, s29, 7
  s_add_u32 s30, s30, s31
  s_add_u32 s30, s30, 16384
  buffer_store_dwordx4 v[64:67], v1, s[8:11], s28 offen sc1
  buffer_store_dword v86, v13, s[8:11], s30 offen sc1
  s_add_u32 s28, s28, 151552
  s_add_u32 s30, s30, 151552
  buffer_store_dwordx4 v[68:71], v1, s[8:11], s28 offen sc1
  buffer_store_dword v87, v13, s[8:11], s30 offen sc1
  s_add_u32 s28, s28, 151552
  buffer_store_dwordx4 v[72:75], v1, s[8:11], s28 offen sc1
  s_add_u32 s28, s28, 151552
  buffer_store_dwordx4 v[76:79], v1, s[8:11], s28 offen sc1
  v_pk_mul_f32 v[128:129], v[128:129], s[64:65]
  v_pk_mul_f32 v[130:131], v[130:131], s[64:65]
  v_pk_mul_f32 v[132:133], v[132:133], s[64:65]
  v_pk_mul_f32 v[134:135], v[134:135], s[64:65]
  v_pk_mul_f32 v[136:137], v[136:137], s[64:65]
  v_pk_mul_f32 v[138:139], v[138:139], s[64:65]
  v_pk_mul_f32 v[140:141], v[140:141], s[64:65]
  v_pk_mul_f32 v[142:143], v[142:143], s[64:65]
  v_pk_mul_f32 v[144:145], v[144:145], s[64:65]
  v_pk_mul_f32 v[146:147], v[146:147], s[64:65]
  v_pk_mul_f32 v[148:149], v[148:149], s[64:65]
  v_pk_mul_f32 v[150:151], v[150:151], s[64:65]
  v_pk_mul_f32 v[152:153], v[152:153], s[64:65]
  v_pk_mul_f32 v[154:155], v[154:155], s[64:65]
  v_pk_mul_f32 v[156:157], v[156:157], s[64:65]
  v_pk_mul_f32 v[158:159], v[158:159], s[64:65]
  v_pk_mul_f32 v[160:161], v[160:161], s[64:65]
  v_pk_mul_f32 v[162:163], v[162:163], s[64:65]
  v_cvt_pk_bf16_f32 v32, v128, v129
  v_cvt_pk_bf16_f32 v33, v130, v131
  v_cvt_pk_bf16_f32 v34, v132, v133
  v_cvt_pk_bf16_f32 v35, v134, v135
  v_cvt_pk_bf16_f32 v48, v136, v137
  v_cvt_pk_bf16_f32 v49, v138, v139
  v_cvt_pk_bf16_f32 v36, v140, v141
  v_cvt_pk_bf16_f32 v37, v142, v143
  v_cvt_pk_bf16_f32 v50, v144, v145
  v_cvt_pk_bf16_f32 v51, v146, v147
  v_cvt_pk_bf16_f32 v40, v148, v149
  v_cvt_pk_bf16_f32 v41, v150, v151
  v_cvt_pk_bf16_f32 v52, v152, v153
  v_cvt_pk_bf16_f32 v53, v154, v155
  v_cvt_pk_bf16_f32 v44, v156, v157
  v_cvt_pk_bf16_f32 v45, v158, v159
  v_cvt_pk_bf16_f32 v46, v160, v161
  v_cvt_pk_bf16_f32 v47, v162, v163
  v_bfi_b32 v38, v4, v48, v50
  v_bfi_b32 v42, v4, v50, v52
  v_bfi_b32 v39, v4, v49, v51
  v_bfi_b32 v43, v4, v51, v53
  v_bfi_b32 v54, v4, v52, v48
  v_bfi_b32 v55, v4, v53, v49
  v_and_b32 v13, 147456, v4
  v_add_u32 v13, v13, v3
  s_lshl_b32 s28, s26, 8
  s_lshl_b32 s29, s25, 2
  s_add_u32 s28, s28, s29
  s_add_u32 s28, s28, s3
  s_mul_i32 s28, s28, 1152
  s_add_u32 s28, s28, 5242880
  buffer_store_dwordx4 v[32:35], v1, s[8:11], s28 offen sc1
  buffer_store_dword v54, v13, s[8:11], s28 offen offset:1024 sc1
  s_add_u32 s28, s28, 73728
  buffer_store_dwordx4 v[36:39], v1, s[8:11], s28 offen sc1
  buffer_store_dword v55, v13, s[8:11], s28 offen offset:1024 sc1
  s_add_u32 s28, s28, 73728
  buffer_store_dwordx4 v[40:43], v1, s[8:11], s28 offen sc1
  s_add_u32 s28, s28, 73728
  buffer_store_dwordx4 v[44:47], v1, s[8:11], s28 offen sc1
  s_mul_i32 s28, s3, 4864
  s_add_u32 s28, s28, 120832
  v_and_b32 v14, 31, v0
  v_mul_u32_u24 v14, 152, v14
  v_and_b32 v16, 8, v4
  v_add3_u32 v14, v14, v16, s28
  v_lshrrev_b32 v16, 4, v0
  v_lshlrev_b32 v16, 3, v16
  v_bfe_u32 v17, v0, 2, 2
  v_add_u32 v16, v16, v17
  v_mul_u32_u24 v16, 152, v16
  v_and_b32 v17, 3, v0
  v_lshlrev_b32 v17, 3, v17
  v_add3_u32 v15, v16, v17, s28
  v_cvt_pk_bf16_f32 v32, v200, v201
  v_cvt_pk_bf16_f32 v33, v202, v203
  ds_write_b64 v14, v[32:33] offset:0
  v_cvt_pk_bf16_f32 v34, v204, v205
  v_cvt_pk_bf16_f32 v35, v206, v207
  ds_write_b64 v14, v[34:35] offset:16
  v_cvt_pk_bf16_f32 v36, v208, v209
  v_cvt_pk_bf16_f32 v37, v210, v211
  ds_write_b64 v14, v[36:37] offset:32
  v_cvt_pk_bf16_f32 v38, v212, v213
  v_cvt_pk_bf16_f32 v39, v214, v215
  ds_write_b64 v14, v[38:39] offset:48
  v_cvt_pk_bf16_f32 v40, v216, v217
  v_cvt_pk_bf16_f32 v41, v218, v219
  ds_write_b64 v14, v[40:41] offset:64
  v_cvt_pk_bf16_f32 v42, v220, v221
  v_cvt_pk_bf16_f32 v43, v222, v223
  ds_write_b64 v14, v[42:43] offset:80
  v_cvt_pk_bf16_f32 v44, v224, v225
  v_cvt_pk_bf16_f32 v45, v226, v227
  ds_write_b64 v14, v[44:45] offset:96
  v_cvt_pk_bf16_f32 v46, v228, v229
  v_cvt_pk_bf16_f32 v47, v230, v231
  ds_write_b64 v14, v[46:47] offset:112
  v_cvt_pk_bf16_f32 v48, v232, v233
  v_cvt_pk_bf16_f32 v49, v234, v235
  ds_write_b64 v14, v[48:49] offset:128
  ds_read_b64_tr_b16 v[96:97], v15 offset:0
  ds_read_b64_tr_b16 v[98:99], v15 offset:608
  ds_read_b64_tr_b16 v[100:101], v15 offset:32
  ds_read_b64_tr_b16 v[102:103], v15 offset:640
  ds_read_b64_tr_b16 v[104:105], v15 offset:64
  ds_read_b64_tr_b16 v[106:107], v15 offset:672
  ds_read_b64_tr_b16 v[108:109], v15 offset:96
  ds_read_b64_tr_b16 v[110:111], v15 offset:704
  ds_read_b64_tr_b16 v[112:113], v15 offset:128
  ds_read_b64_tr_b16 v[114:115], v15 offset:736
  s_mul_i32 s30, s3, 1216
  s_add_u32 s30, s30, 140288
  v_lshrrev_b32 v18, 5, v0
  v_mul_u32_u24 v18, 608, v18
  v_bfe_u32 v19, v0, 4, 1
  v_mul_u32_u24 v19, 304, v19
  v_add3_u32 v18, v18, v19, s30
  v_and_b32 v19, 15, v0
  v_bfe_u32 v20, v0, 2, 2
  v_mul_u32_u24 v20, 4864, v20
  v_bfe_u32 v21, v0, 1, 1
  v_mul_u32_u24 v21, 608, v21
  v_and_b32 v22, 1, v0
  v_mul_u32_u24 v22, 304, v22
  v_add3_u32 v20, v20, v21, v22
  v_bfe_u32 v21, v0, 4, 2
  v_min_u32 v21, 1, v21
  v_lshlrev_b32 v21, 20, v21
  v_add3_u32 v20, v20, v21, s30
  v_mov_b32 v88, 0x3f803f80
  v_mov_b32 v89, 0x3f803f80
  v_mov_b32 v90, 0x3f803f80
  v_mov_b32 v91, 0x3f803f80
  ds_write_b128 v20, v[88:91] offset:288
  v_add_u32 v20, 0, v19
  v_mul_u32_u24 v21, 57, v20
  v_lshrrev_b32 v21, 10, v21
  v_mul_u32_u24 v21, 4576, v21
  v_lshlrev_b32 v20, 4, v20
  v_add3_u32 v20, v20, v21, v18
  s_waitcnt lgkmcnt(9)
  ds_write_b128 v20, v[96:99]
  v_add_u32 v22, 16, v19
  v_mul_u32_u24 v23, 57, v22
  v_lshrrev_b32 v23, 10, v23
  v_mul_u32_u24 v23, 4576, v23
  v_lshlrev_b32 v22, 4, v22
  v_add3_u32 v22, v22, v23, v18
  s_waitcnt lgkmcnt(8)
  ds_write_b128 v22, v[100:103]
  v_add_u32 v20, 32, v19
  v_mul_u32_u24 v21, 57, v20
  v_lshrrev_b32 v21, 10, v21
  v_mul_u32_u24 v21, 4576, v21
  v_lshlrev_b32 v20, 4, v20
  v_add3_u32 v20, v20, v21, v18
  s_waitcnt lgkmcnt(7)
  ds_write_b128 v20, v[104:107]
  v_add_u32 v22, 48, v19
  v_mul_u32_u24 v23, 57, v22
  v_lshrrev_b32 v23, 10, v23
  v_mul_u32_u24 v23, 4576, v23
  v_lshlrev_b32 v22, 4, v22
  v_add3_u32 v22, v22, v23, v18
  s_waitcnt lgkmcnt(6)
  ds_write_b128 v22, v[108:111]
  v_add_u32 v20, 64, v19
  v_mul_u32_u24 v21, 57, v20
  v_lshrrev_b32 v21, 10, v21
  v_mul_u32_u24 v21, 4576, v21
  v_lshlrev_b32 v20, 4, v20
  v_add3_u32 v20, v20, v21, v18
  v_bfe_u32 v21, v0, 3, 1
  v_lshlrev_b32 v21, 20, v21
  v_or_b32 v20, v20, v21
  s_waitcnt lgkmcnt(5)
  ds_write_b128 v20, v[112:115]
  s_waitcnt lgkmcnt(0)
  s_barrier
  s_branch P1_SIGNAL
P1_EPI_B:
  s_mov_b32 s64, 0x3fb8aa3b
  s_mov_b32 s65, 0x3fb8aa3b
  s_mov_b32 s66, 0x358637bd
  s_mov_b32 s67, 0x358637bd
  s_lshl_b32 s28, s3, 5
  v_and_b32 v14, 31, v0
  v_add_u32 v14, s28, v14
  v_mul_u32_u24 v14, 296, v14
  v_add_u32 v14, 120832, v14
  v_mov_b32 v16, 0x3f803f80
  v_mov_b32 v17, 0x3f803f80
  ds_write_b64 v14, v[16:17] offset:288
  v_and_b32 v18, 8, v4
  v_add_u32 v14, v14, v18
  v_cvt_pk_bf16_f32 v32, v200, v201
  v_cvt_pk_bf16_f32 v33, v202, v203
  ds_write_b64 v14, v[32:33] offset:144
  v_cvt_pk_bf16_f32 v34, v204, v205
  v_cvt_pk_bf16_f32 v35, v206, v207
  ds_write_b64 v14, v[34:35] offset:160
  v_cvt_pk_bf16_f32 v36, v208, v209
  v_cvt_pk_bf16_f32 v37, v210, v211
  ds_write_b64 v14, v[36:37] offset:176
  v_cvt_pk_bf16_f32 v38, v212, v213
  v_cvt_pk_bf16_f32 v39, v214, v215
  ds_write_b64 v14, v[38:39] offset:192
  v_cvt_pk_bf16_f32 v40, v216, v217
  v_cvt_pk_bf16_f32 v41, v218, v219
  ds_write_b64 v14, v[40:41] offset:208
  v_cvt_pk_bf16_f32 v42, v220, v221
  v_cvt_pk_bf16_f32 v43, v222, v223
  ds_write_b64 v14, v[42:43] offset:224
  v_cvt_pk_bf16_f32 v44, v224, v225
  v_cvt_pk_bf16_f32 v45, v226, v227
  ds_write_b64 v14, v[44:45] offset:240
  v_cvt_pk_bf16_f32 v46, v228, v229
  v_cvt_pk_bf16_f32 v47, v230, v231
  ds_write_b64 v14, v[46:47] offset:256
  v_cvt_pk_bf16_f32 v48, v232, v233
  v_cvt_pk_bf16_f32 v49, v234, v235
  ds_write_b64 v14, v[48:49] offset:272
  v_pk_mul_f32 v[20:21], v[164:165], s[64:65]
  v_pk_mul_f32 v[22:23], v[166:167], s[64:65]
  v_pk_mul_f32 v[24:25], v[168:169], s[64:65]
  v_pk_mul_f32 v[26:27], v[170:171], s[64:65]
  v_exp_f32_e64 v20, v20 clamp
  v_exp_f32_e64 v21, v21 clamp
  v_exp_f32_e64 v22, v22 clamp
  v_exp_f32_e64 v23, v23 clamp
  v_exp_f32_e64 v24, v24 clamp
  v_exp_f32_e64 v25, v25 clamp
  v_exp_f32_e64 v26, v26 clamp
  v_exp_f32_e64 v27, v27 clamp
  v_max_f32 v164, 0, v164
  v_max_f32 v165, 0, v165
  v_max_f32 v166, 0, v166
  v_max_f32 v167, 0, v167
  v_max_f32 v168, 0, v168
  v_max_f32 v169, 0, v169
  v_max_f32 v170, 0, v170
  v_max_f32 v171, 0, v171
  v_pk_add_f32 v[164:165], v[164:165], v[20:21]
  v_pk_add_f32 v[166:167], v[166:167], v[22:23]
  v_pk_add_f32 v[168:169], v[168:169], v[24:25]
  v_pk_add_f32 v[170:171], v[170:171], v[26:27]
  v_pk_add_f32 v[164:165], v[164:165], s[66:67]
  v_pk_add_f32 v[166:167], v[166:167], s[66:67]
  v_pk_add_f32 v[168:169], v[168:169], s[66:67]
  v_pk_add_f32 v[170:171], v[170:171], s[66:67]
  v_pk_mul_f32 v[20:21], v[172:173], s[64:65]
  v_pk_mul_f32 v[22:23], v[174:175], s[64:65]
  v_pk_mul_f32 v[24:25], v[176:177], s[64:65]
  v_pk_mul_f32 v[26:27], v[178:179], s[64:65]
  v_exp_f32_e64 v20, v20 clamp
  v_exp_f32_e64 v21, v21 clamp
  v_exp_f32_e64 v22, v22 clamp
  v_exp_f32_e64 v23, v23 clamp
  v_exp_f32_e64 v24, v24 clamp
  v_exp_f32_e64 v25, v25 clamp
  v_exp_f32_e64 v26, v26 clamp
  v_exp_f32_e64 v27, v27 clamp
  v_max_f32 v172, 0, v172
  v_max_f32 v173, 0, v173
  v_max_f32 v174, 0, v174
  v_max_f32 v175, 0, v175
  v_max_f32 v176, 0, v176
  v_max_f32 v177, 0, v177
  v_max_f32 v178, 0, v178
  v_max_f32 v179, 0, v179
  v_pk_add_f32 v[172:173], v[172:173], v[20:21]
  v_pk_add_f32 v[174:175], v[174:175], v[22:23]
  v_pk_add_f32 v[176:177], v[176:177], v[24:25]
  v_pk_add_f32 v[178:179], v[178:179], v[26:27]
  v_pk_add_f32 v[172:173], v[172:173], s[66:67]
  v_pk_add_f32 v[174:175], v[174:175], s[66:67]
  v_pk_add_f32 v[176:177], v[176:177], s[66:67]
  v_pk_add_f32 v[178:179], v[178:179], s[66:67]
  v_pk_mul_f32 v[20:21], v[180:181], s[64:65]
  v_pk_mul_f32 v[22:23], v[182:183], s[64:65]
  v_pk_mul_f32 v[24:25], v[184:185], s[64:65]
  v_pk_mul_f32 v[26:27], v[186:187], s[64:65]
  v_exp_f32_e64 v20, v20 clamp
  v_exp_f32_e64 v21, v21 clamp
  v_exp_f32_e64 v22, v22 clamp
  v_exp_f32_e64 v23, v23 clamp
  v_exp_f32_e64 v24, v24 clamp
  v_exp_f32_e64 v25, v25 clamp
  v_exp_f32_e64 v26, v26 clamp
  v_exp_f32_e64 v27, v27 clamp
  v_max_f32 v180, 0, v180
  v_max_f32 v181, 0, v181
  v_max_f32 v182, 0, v182
  v_max_f32 v183, 0, v183
  v_max_f32 v184, 0, v184
  v_max_f32 v185, 0, v185
  v_max_f32 v186, 0, v186
  v_max_f32 v187, 0, v187
  v_pk_add_f32 v[180:181], v[180:181], v[20:21]
  v_pk_add_f32 v[182:183], v[182:183], v[22:23]
  v_pk_add_f32 v[184:185], v[184:185], v[24:25]
  v_pk_add_f32 v[186:187], v[186:187], v[26:27]
  v_pk_add_f32 v[180:181], v[180:181], s[66:67]
  v_pk_add_f32 v[182:183], v[182:183], s[66:67]
  v_pk_add_f32 v[184:185], v[184:185], s[66:67]
  v_pk_add_f32 v[186:187], v[186:187], s[66:67]
  v_pk_mul_f32 v[20:21], v[188:189], s[64:65]
  v_pk_mul_f32 v[22:23], v[190:191], s[64:65]
  v_pk_mul_f32 v[24:25], v[192:193], s[64:65]
  v_pk_mul_f32 v[26:27], v[194:195], s[64:65]
  v_exp_f32_e64 v20, v20 clamp
  v_exp_f32_e64 v21, v21 clamp
  v_exp_f32_e64 v22, v22 clamp
  v_exp_f32_e64 v23, v23 clamp
  v_exp_f32_e64 v24, v24 clamp
  v_exp_f32_e64 v25, v25 clamp
  v_exp_f32_e64 v26, v26 clamp
  v_exp_f32_e64 v27, v27 clamp
  v_max_f32 v188, 0, v188
  v_max_f32 v189, 0, v189
  v_max_f32 v190, 0, v190
  v_max_f32 v191, 0, v191
  v_max_f32 v192, 0, v192
  v_max_f32 v193, 0, v193
  v_max_f32 v194, 0, v194
  v_max_f32 v195, 0, v195
  v_pk_add_f32 v[188:189], v[188:189], v[20:21]
  v_pk_add_f32 v[190:191], v[190:191], v[22:23]
  v_pk_add_f32 v[192:193], v[192:193], v[24:25]
  v_pk_add_f32 v[194:195], v[194:195], v[26:27]
  v_pk_add_f32 v[188:189], v[188:189], s[66:67]
  v_pk_add_f32 v[190:191], v[190:191], s[66:67]
  v_pk_add_f32 v[192:193], v[192:193], s[66:67]
  v_pk_add_f32 v[194:195], v[194:195], s[66:67]
  v_pk_mul_f32 v[20:21], v[196:197], s[64:65]
  v_pk_mul_f32 v[22:23], v[198:199], s[64:65]
  v_exp_f32_e64 v20, v20 clamp
  v_exp_f32_e64 v21, v21 clamp
  v_exp_f32_e64 v22, v22 clamp
  v_exp_f32_e64 v23, v23 clamp
  v_max_f32 v196, 0, v196
  v_max_f32 v197, 0, v197
  v_max_f32 v198, 0, v198
  v_max_f32 v199, 0, v199
  v_pk_add_f32 v[196:197], v[196:197], v[20:21]
  v_pk_add_f32 v[198:199], v[198:199], v[22:23]
  v_pk_add_f32 v[196:197], v[196:197], s[66:67]
  v_pk_add_f32 v[198:199], v[198:199], s[66:67]
  v_cvt_pk_bf16_f32 v64, v164, v165
  v_cvt_pk_bf16_f32 v65, v166, v167
  ds_write_b64 v14, v[64:65] offset:0
  v_cvt_pk_bf16_f32 v66, v168, v169
  v_cvt_pk_bf16_f32 v67, v170, v171
  ds_write_b64 v14, v[66:67] offset:16
  v_cvt_pk_bf16_f32 v68, v172, v173
  v_cvt_pk_bf16_f32 v69, v174, v175
  ds_write_b64 v14, v[68:69] offset:32
  v_cvt_pk_bf16_f32 v70, v176, v177
  v_cvt_pk_bf16_f32 v71, v178, v179
  ds_write_b64 v14, v[70:71] offset:48
  v_cvt_pk_bf16_f32 v72, v180, v181
  v_cvt_pk_bf16_f32 v73, v182, v183
  ds_write_b64 v14, v[72:73] offset:64
  v_cvt_pk_bf16_f32 v74, v184, v185
  v_cvt_pk_bf16_f32 v75, v186, v187
  ds_write_b64 v14, v[74:75] offset:80
  v_cvt_pk_bf16_f32 v76, v188, v189
  v_cvt_pk_bf16_f32 v77, v190, v191
  ds_write_b64 v14, v[76:77] offset:96
  v_cvt_pk_bf16_f32 v78, v192, v193
  v_cvt_pk_bf16_f32 v79, v194, v195
  ds_write_b64 v14, v[78:79] offset:112
  v_cvt_pk_bf16_f32 v80, v196, v197
  v_cvt_pk_bf16_f32 v81, v198, v199
  ds_write_b64 v14, v[80:81] offset:128
  s_waitcnt lgkmcnt(0)
  s_barrier
  s_mul_i32 s28, s3, 18
  s_lshr_b32 s28, s28, 2
  v_lshrrev_b32 v17, 5, v0
  v_lshlrev_b32 v17, 3, v17
  v_bfe_u32 v18, v0, 2, 2
  v_add_u32 v17, v17, v18
  v_mul_u32_u24 v17, 296, v17
  v_add_u32 v17, 120832, v17
  v_bfe_u32 v18, v0, 4, 1
  v_lshlrev_b32 v18, 2, v18
  v_and_b32 v19, 3, v0
  v_add_u32 v18, v18, v19
  v_add_u32 v19, s28, v18
  v_lshl_add_u32 v15, v19, 3, v17
  v_add_u32 v19, 18, v19
  v_cmp_eq_u32 vcc, 5, v18
  v_mov_b32 v20, 36
  s_nop 0
  v_cndmask_b32 v19, v19, v20, vcc
  v_lshl_add_u32 v16, v19, 3, v17
  ds_read_b64_tr_b16 v[96:97], v15 offset:0
  ds_read_b64_tr_b16 v[104:105], v16 offset:0
  ds_read_b64_tr_b16 v[98:99], v15 offset:1184
  ds_read_b64_tr_b16 v[106:107], v16 offset:1184
  ds_read_b64_tr_b16 v[100:101], v15 offset:4736
  ds_read_b64_tr_b16 v[108:109], v16 offset:4736
  ds_read_b64_tr_b16 v[102:103], v15 offset:5920
  ds_read_b64_tr_b16 v[110:111], v16 offset:5920
  s_waitcnt lgkmcnt(4)
  v_mfma_f32_32x32x16_bf16 v[112:127], v[96:99], v[104:107], 0
  ds_read_b64_tr_b16 v[96:97], v15 offset:9472
  ds_read_b64_tr_b16 v[104:105], v16 offset:9472
  ds_read_b64_tr_b16 v[98:99], v15 offset:10656
  ds_read_b64_tr_b16 v[106:107], v16 offset:10656
  s_waitcnt lgkmcnt(4)
  v_mfma_f32_32x32x16_bf16 v[112:127], v[100:103], v[108:111], v[112:127]
  ds_read_b64_tr_b16 v[100:101], v15 offset:14208
  ds_read_b64_tr_b16 v[108:109], v16 offset:14208
  ds_read_b64_tr_b16 v[102:103], v15 offset:15392
  ds_read_b64_tr_b16 v[110:111], v16 offset:15392
  s_waitcnt lgkmcnt(4)
  v_mfma_f32_32x32x16_bf16 v[112:127], v[96:99], v[104:107], v[112:127]
  ds_read_b64_tr_b16 v[96:97], v15 offset:18944
  ds_read_b64_tr_b16 v[104:105], v16 offset:18944
  ds_read_b64_tr_b16 v[98:99], v15 offset:20128
  ds_read_b64_tr_b16 v[106:107], v16 offset:20128
  s_waitcnt lgkmcnt(4)
  v_mfma_f32_32x32x16_bf16 v[112:127], v[100:103], v[108:111], v[112:127]
  ds_read_b64_tr_b16 v[100:101], v15 offset:23680
  ds_read_b64_tr_b16 v[108:109], v16 offset:23680
  ds_read_b64_tr_b16 v[102:103], v15 offset:24864
  ds_read_b64_tr_b16 v[110:111], v16 offset:24864
  s_waitcnt lgkmcnt(4)
  v_mfma_f32_32x32x16_bf16 v[112:127], v[96:99], v[104:107], v[112:127]
  ds_read_b64_tr_b16 v[96:97], v15 offset:28416
  ds_read_b64_tr_b16 v[104:105], v16 offset:28416
  ds_read_b64_tr_b16 v[98:99], v15 offset:29600
  ds_read_b64_tr_b16 v[106:107], v16 offset:29600
  s_waitcnt lgkmcnt(4)
  v_mfma_f32_32x32x16_bf16 v[112:127], v[100:103], v[108:111], v[112:127]
  ds_read_b64_tr_b16 v[100:101], v15 offset:33152
  ds_read_b64_tr_b16 v[108:109], v16 offset:33152
  ds_read_b64_tr_b16 v[102:103], v15 offset:34336
  ds_read_b64_tr_b16 v[110:111], v16 offset:34336
  s_waitcnt lgkmcnt(4)
  v_mfma_f32_32x32x16_bf16 v[112:127], v[96:99], v[104:107], v[112:127]
  s_waitcnt lgkmcnt(0)
  v_mfma_f32_32x32x16_bf16 v[112:127], v[100:103], v[108:111], v[112:127]
  v_pk_mul_f32 v[20:21], v[128:129], s[64:65]
  v_pk_mul_f32 v[22:23], v[130:131], s[64:65]
  v_pk_mul_f32 v[24:25], v[132:133], s[64:65]
  v_pk_mul_f32 v[26:27], v[134:135], s[64:65]
  v_exp_f32_e64 v20, v20 clamp
  v_exp_f32_e64 v21, v21 clamp
  v_exp_f32_e64 v22, v22 clamp
  v_exp_f32_e64 v23, v23 clamp
  v_exp_f32_e64 v24, v24 clamp
  v_exp_f32_e64 v25, v25 clamp
  v_exp_f32_e64 v26, v26 clamp
  v_exp_f32_e64 v27, v27 clamp
  v_max_f32 v128, 0, v128
  v_max_f32 v129, 0, v129
  v_max_f32 v130, 0, v130
  v_max_f32 v131, 0, v131
  v_max_f32 v132, 0, v132
  v_max_f32 v133, 0, v133
  v_max_f32 v134, 0, v134
  v_max_f32 v135, 0, v135
  v_pk_add_f32 v[128:129], v[128:129], v[20:21]
  v_pk_add_f32 v[130:131], v[130:131], v[22:23]
  v_pk_add_f32 v[132:133], v[132:133], v[24:25]
  v_pk_add_f32 v[134:135], v[134:135], v[26:27]
  v_pk_add_f32 v[128:129], v[128:129], s[66:67]
  v_pk_add_f32 v[130:131], v[130:131], s[66:67]
  v_pk_add_f32 v[132:133], v[132:133], s[66:67]
  v_pk_add_f32 v[134:135], v[134:135], s[66:67]
  v_pk_mul_f32 v[20:21], v[136:137], s[64:65]
  v_pk_mul_f32 v[22:23], v[138:139], s[64:65]
  v_pk_mul_f32 v[24:25], v[140:141], s[64:65]
  v_pk_mul_f32 v[26:27], v[142:143], s[64:65]
  v_exp_f32_e64 v20, v20 clamp
  v_exp_f32_e64 v21, v21 clamp
  v_exp_f32_e64 v22, v22 clamp
  v_exp_f32_e64 v23, v23 clamp
  v_exp_f32_e64 v24, v24 clamp
  v_exp_f32_e64 v25, v25 clamp
  v_exp_f32_e64 v26, v26 clamp
  v_exp_f32_e64 v27, v27 clamp
  v_max_f32 v136, 0, v136
  v_max_f32 v137, 0, v137
  v_max_f32 v138, 0, v138
  v_max_f32 v139, 0, v139
  v_max_f32 v140, 0, v140
  v_max_f32 v141, 0, v141
  v_max_f32 v142, 0, v142
  v_max_f32 v143, 0, v143
  v_pk_add_f32 v[136:137], v[136:137], v[20:21]
  v_pk_add_f32 v[138:139], v[138:139], v[22:23]
  v_pk_add_f32 v[140:141], v[140:141], v[24:25]
  v_pk_add_f32 v[142:143], v[142:143], v[26:27]
  v_pk_add_f32 v[136:137], v[136:137], s[66:67]
  v_pk_add_f32 v[138:139], v[138:139], s[66:67]
  v_pk_add_f32 v[140:141], v[140:141], s[66:67]
  v_pk_add_f32 v[142:143], v[142:143], s[66:67]
  v_pk_mul_f32 v[20:21], v[144:145], s[64:65]
  v_pk_mul_f32 v[22:23], v[146:147], s[64:65]
  v_pk_mul_f32 v[24:25], v[148:149], s[64:65]
  v_pk_mul_f32 v[26:27], v[150:151], s[64:65]
  v_exp_f32_e64 v20, v20 clamp
  v_exp_f32_e64 v21, v21 clamp
  v_exp_f32_e64 v22, v22 clamp
  v_exp_f32_e64 v23, v23 clamp
  v_exp_f32_e64 v24, v24 clamp
  v_exp_f32_e64 v25, v25 clamp
  v_exp_f32_e64 v26, v26 clamp
  v_exp_f32_e64 v27, v27 clamp
  v_max_f32 v144, 0, v144
  v_max_f32 v145, 0, v145
  v_max_f32 v146, 0, v146
  v_max_f32 v147, 0, v147
  v_max_f32 v148, 0, v148
  v_max_f32 v149, 0, v149
  v_max_f32 v150, 0, v150
  v_max_f32 v151, 0, v151
  v_pk_add_f32 v[144:145], v[144:145], v[20:21]
  v_pk_add_f32 v[146:147], v[146:147], v[22:23]
  v_pk_add_f32 v[148:149], v[148:149], v[24:25]
  v_pk_add_f32 v[150:151], v[150:151], v[26:27]
  v_pk_add_f32 v[144:145], v[144:145], s[66:67]
  v_pk_add_f32 v[146:147], v[146:147], s[66:67]
  v_pk_add_f32 v[148:149], v[148:149], s[66:67]
  v_pk_add_f32 v[150:151], v[150:151], s[66:67]
  v_pk_mul_f32 v[20:21], v[152:153], s[64:65]
  v_pk_mul_f32 v[22:23], v[154:155], s[64:65]
  v_pk_mul_f32 v[24:25], v[156:157], s[64:65]
  v_pk_mul_f32 v[26:27], v[158:159], s[64:65]
  v_exp_f32_e64 v20, v20 clamp
  v_exp_f32_e64 v21, v21 clamp
  v_exp_f32_e64 v22, v22 clamp
  v_exp_f32_e64 v23, v23 clamp
  v_exp_f32_e64 v24, v24 clamp
  v_exp_f32_e64 v25, v25 clamp
  v_exp_f32_e64 v26, v26 clamp
  v_exp_f32_e64 v27, v27 clamp
  v_max_f32 v152, 0, v152
  v_max_f32 v153, 0, v153
  v_max_f32 v154, 0, v154
  v_max_f32 v155, 0, v155
  v_max_f32 v156, 0, v156
  v_max_f32 v157, 0, v157
  v_max_f32 v158, 0, v158
  v_max_f32 v159, 0, v159
  v_pk_add_f32 v[152:153], v[152:153], v[20:21]
  v_pk_add_f32 v[154:155], v[154:155], v[22:23]
  v_pk_add_f32 v[156:157], v[156:157], v[24:25]
  v_pk_add_f32 v[158:159], v[158:159], v[26:27]
  v_pk_add_f32 v[152:153], v[152:153], s[66:67]
  v_pk_add_f32 v[154:155], v[154:155], s[66:67]
  v_pk_add_f32 v[156:157], v[156:157], s[66:67]
  v_pk_add_f32 v[158:159], v[158:159], s[66:67]
  v_pk_mul_f32 v[20:21], v[160:161], s[64:65]
  v_pk_mul_f32 v[22:23], v[162:163], s[64:65]
  v_exp_f32_e64 v20, v20 clamp
  v_exp_f32_e64 v21, v21 clamp
  v_exp_f32_e64 v22, v22 clamp
  v_exp_f32_e64 v23, v23 clamp
  v_max_f32 v160, 0, v160
  v_max_f32 v161, 0, v161
  v_max_f32 v162, 0, v162
  v_max_f32 v163, 0, v163
  v_pk_add_f32 v[160:161], v[160:161], v[20:21]
  v_pk_add_f32 v[162:163], v[162:163], v[22:23]
  v_pk_add_f32 v[160:161], v[160:161], s[66:67]
  v_pk_add_f32 v[162:163], v[162:163], s[66:67]
  s_mov_b32 s30, 0x43120
  s_cmp_eq_u32 s3, 1
  s_cselect_b32 s30, 0x12034, s30
  s_cmp_eq_u32 s3, 2
  s_cselect_b32 s30, 0x41203, s30
  s_cmp_eq_u32 s3, 3
  s_cselect_b32 s30, 0x31204, s30
  s_and_b32 s28, s3, 1
  s_lshl_b32 s28, s28, 1
  v_and_b32 v16, 31, v0
  v_subrev_u32 v17, s28, v16
  v_cmp_gt_u32 vcc, 18, v17
  v_mov_b32 v18, 2147483648
  v_mul_u32_u24 v17, 96, v17
  v_cndmask_b32 v17, v18, v17, vcc
  v_cmp_eq_u32 vcc, 20, v16
  v_mov_b32 v18, 1728
  v_and_b32 v19, 4, v4
  v_cndmask_b32 v17, v17, v18, vcc
  s_lshl_b32 s28, s3, 11
  s_add_u32 s28, s28, 102400
  v_and_b32 v20, 2147483648, v17
  v_lshrrev_b32 v20, 11, v20
  v_and_b32 v17, 0xffff, v17
  v_add3_u32 v17, v17, v20, s28
  v_add_u32 v20, 0, v19
  v_bfe_u32 v20, s30, v20, 4
  v_lshl_add_u32 v21, v20, 4, v17
  v_add_u32 v20, 8, v19
  v_bfe_u32 v20, s30, v20, 4
  v_lshl_add_u32 v22, v20, 4, v17
  v_add_u32 v20, 16, v19
  v_bfe_u32 v20, s30, v20, 4
  v_lshl_add_u32 v23, v20, 4, v17
  v_and_b32 v20, 1048576, v4
  v_or_b32 v23, v23, v20
  ds_write_b128 v21, v[112:115]
  ds_write_b128 v22, v[116:119]
  ds_write_b128 v23, v[120:123]
  v_add_u32 v16, s28, v1
  ds_read_b128 v[176:179], v16
  ds_read_b128 v[180:183], v16 offset:1024
  v_cvt_pk_bf16_f32 v184, v128, v129
  v_cvt_pk_bf16_f32 v185, v130, v131
  v_cvt_pk_bf16_f32 v186, v132, v133
  v_cvt_pk_bf16_f32 v187, v134, v135
  v_cvt_pk_bf16_f32 v200, v136, v137
  v_cvt_pk_bf16_f32 v201, v138, v139
  v_cvt_pk_bf16_f32 v188, v140, v141
  v_cvt_pk_bf16_f32 v189, v142, v143
  v_cvt_pk_bf16_f32 v202, v144, v145
  v_cvt_pk_bf16_f32 v203, v146, v147
  v_cvt_pk_bf16_f32 v192, v148, v149
  v_cvt_pk_bf16_f32 v193, v150, v151
  v_cvt_pk_bf16_f32 v204, v152, v153
  v_cvt_pk_bf16_f32 v205, v154, v155
  v_cvt_pk_bf16_f32 v196, v156, v157
  v_cvt_pk_bf16_f32 v197, v158, v159
  v_cvt_pk_bf16_f32 v198, v160, v161
  v_cvt_pk_bf16_f32 v199, v162, v163
  v_bfi_b32 v190, v4, v200, v202
  v_bfi_b32 v194, v4, v202, v204
  v_bfi_b32 v191, v4, v201, v203
  v_bfi_b32 v195, v4, v203, v205
  v_bfi_b32 v206, v4, v204, v200
  v_bfi_b32 v207, v4, v205, v201
  s_waitcnt lgkmcnt(0)
  s_branch P2_SETUP
P1_SIGNAL:
  s_waitcnt vmcnt(0)
  s_mov_b64 exec, 1
  v_mov_b32 v12, 163328
  v_mov_b32 v13, 1
  ds_add_rtn_u32 v14, v12, v13
  s_waitcnt lgkmcnt(0)
  v_readfirstlane_b32 s28, v14
  s_nop 3
  s_cmp_eq_u32 s28, 7
  s_cbranch_scc0 P1_CS_N
  s_lshl_b32 s28, s24, 14
  s_lshl_b32 s29, s26, 11
  s_add_u32 s28, s28, s29
  s_lshl_b32 s29, s25, 7
  s_add_u32 s28, s28, s29
  s_add_u32 s28, s28, 17825792
  v_mov_b32 v12, 0
  buffer_store_dword v13, v12, s[8:11], s28 offen sc1
P1_CS_N:
  s_mov_b64 exec, -1
P2_SETUP:
  s_lshl_b32 s37, s33, 3
  s_add_u32 s37, s37, s3
  s_lshl_b32 s28, s32, 6
  s_add_u32 s28, s28, s37
  s_mul_i32 s38, s28, 1152
  s_mul_i32 s58, s32, 151552
  s_add_u32 s58, s58, 37888
  s_mov_b32 s59, 37888
  s_lshl_b32 s60, s3, 10
  s_add_u32 s61, s60, 32768
  s_min_u32 s61, s61, 36864
  v_mov_b32 v5, v1
  v_mov_b32 v6, v3
  v_mov_b32 v14, 0xdddddddd
  v_and_b32 v127, 15, v0
  v_lshlrev_b32 v127, 7, v127
  v_mov_b32 v126, 0
  v_lshrrev_b32 v144, 4, v0
  v_mul_u32_u24 v144, 8192, v144
  v_and_b32 v145, 15, v0
  v_lshl_add_u32 v144, v145, 4, v144
  v_lshlrev_b32 v145, 3, v145
  s_lshl_b32 s28, s3, 7
  s_add_u32 s28, s28, 151552
  v_add_u32 v145, s28, v145
  v_and_b32 v200, 147456, v4
  v_add_u32 v200, v200, v3
  v_mov_b32 v13, 0
  v_mov_b32 v73, 0
  v_mov_b32 v75, 0
  v_and_b32 v100, 31, v0
  v_cmp_eq_u32 vcc, 22, v100
  v_mov_b32 v102, 18
  s_mov_b32 s28, 0x0047ffff
  v_cndmask_b32 v15, v100, v102, vcc
  v_lshrrev_b32 v101, v100, s28
  v_min_u32 v15, 18, v15
  v_and_b32 v101, 1, v101
  v_xor_b32 v101, 1, v101
  v_lshlrev_b32 v101, 20, v101
  v_lshlrev_b32 v102, 4, v15
  v_and_b32 v103, 304, v4
  v_add_u32 v7, v102, v103
  v_or_b32 v7, v7, v101
  v_bfe_u32 v100, v0, 4, 1
  v_lshlrev_b32 v100, 14, v100
  v_and_b32 v101, 15, v0
  v_lshlrev_b32 v101, 4, v101
  v_add_u32 v100, v100, v101
  v_and_b32 v101, 256, v4
  v_add_u32 v102, v100, v101
  v_and_b32 v101, 2147483648, v4
  v_or_b32 v103, v3, v101
  s_mul_i32 s28, s37, 32768
  s_lshr_b32 s29, s32, 1
  s_lshl_b32 s29, s29, 10
  s_and_b32 s30, s32, 1
  s_lshl_b32 s30, s30, 9
  s_add_u32 s29, s29, s30
  s_add_u32 s35, s28, s29
  s_lshl_b32 s28, s37, 12
  s_lshl_b32 s29, s32, 7
  s_add_u32 s36, s28, s29
  v_mov_b32 v48, 0
  v_mov_b32 v49, 0
  v_mov_b32 v50, 0
  v_mov_b32 v51, 0
  v_mov_b32 v52, 0
  v_mov_b32 v53, 0
  v_mov_b32 v54, 0
  v_mov_b32 v55, 0
  v_mov_b32 v56, 0
  v_mov_b32 v57, 0
  v_mov_b32 v58, 0
  v_mov_b32 v59, 0
  v_mov_b32 v60, 0
  v_mov_b32 v61, 0
  v_mov_b32 v62, 0
  v_mov_b32 v63, 0
  v_mov_b32 v40, 0
  v_mov_b32 v41, 0
  v_mov_b32 v42, 0
  v_mov_b32 v43, 0
  v_mov_b32 v44, 0
  v_mov_b32 v45, 0
  v_mov_b32 v46, 0
  v_mov_b32 v47, 0
  v_mov_b32 v80, 0
  v_mov_b32 v81, 0
  v_mov_b32 v82, 0
  v_mov_b32 v83, 0
  s_mov_b32 s34, 0
  s_lshr_b32 s62, s3, 2
  s_cmp_eq_u32 s24, 1
  s_cselect_b32 s63, s62, 99
  s_cselect_b32 s73, s3, 99
  s_cmp_eq_u32 s63, 0
  s_cselect_b32 s63, 0, 99
  s_cmp_eq_u32 s73, 0
  s_cselect_b32 s73, 0, 99
  s_mul_i32 s28, s3, 1152
  s_add_u32 s28, s28, 75776
  v_add_u32 v104, s28, v1
  v_add_u32 v105, s28, v3
  s_waitcnt vmcnt(0)
  s_barrier
  ds_read_b128 v[8:11], v104
  ds_read_b32 v12, v105 offset:1024
  ds_read_b128 v[64:67], v5 offset:0
  ds_read_b32 v72, v6 offset:16384
  ds_read_b128 v[68:71], v5 offset:1024
  ds_read_b32 v74, v6 offset:16512
  ds_read_b128 v[76:79], v7 offset:18432
  v_not_b32 v105, v4
  s_waitcnt lgkmcnt(3)
  v_and_b32 v12, v12, v105
  s_nop 1
  v_mfma_f32_32x32x16_bf16 v[16:31], v[64:67], v[8:11], 0
  v_mfma_f32_32x32x8_bf16 v[16:31], v[72:73], v[12:13], v[16:31]
  s_nop 7
  s_nop 7
  .p2align 6
  s_cmp_eq_u32 s63, 0
  s_cbranch_scc0 P2_U00
  s_lshl_b32 s74, s26, 2
  s_add_u32 s74, s74, s3
  s_mul_i32 s74, s74, 32768
  s_mul_i32 s29, s25, 2048
  s_add_u32 s74, s74, s29
  s_add_u32 s74, s74, 10485760
  s_lshl_b32 s75, s26, 8
  s_lshl_b32 s29, s25, 2
  s_add_u32 s75, s75, s29
  s_add_u32 s75, s75, s3
  s_mul_i32 s75, s75, 1152
  s_add_u32 s75, s75, 7864320
  buffer_store_dwordx4 v[176:179], v1, s[8:11], s74 offen sc1
P2_U00:
  s_add_u32 s28, s60, 0
  s_add_u32 m0, s28, s59
  s_add_u32 s28, s28, s58
  buffer_load_dwordx4 v1, s[8:11], s28 offen sc1 lds
  s_setprio 0
  v_smfmac_f32_32x32x32_bf16 v[48:63], v[80:83], v[40:47], v14
  ds_read_b128 v[80:83], v7 offset:19040
  v_exp_f32 v16, v16
  v_exp_f32 v17, v17
  v_exp_f32 v18, v18
  v_exp_f32 v19, v19
  s_waitcnt lgkmcnt(2)
  v_mfma_f32_32x32x16_bf16 v[32:47], v[68:71], v[8:11], 0
  v_exp_f32 v20, v20
  v_exp_f32 v21, v21
  v_exp_f32 v22, v22
  v_exp_f32 v23, v23
  v_mfma_f32_32x32x8_bf16 v[32:47], v[74:75], v[12:13], v[32:47]
  ds_read_b128 v[64:67], v5 offset:2048
  ds_read_b32 v72, v6 offset:16640
  v_exp_f32 v24, v24
  v_exp_f32 v25, v25
  v_exp_f32 v26, v26
  v_exp_f32 v27, v27
  s_waitcnt lgkmcnt(3)
  v_smfmac_f32_32x32x32_bf16 v[48:63], v[76:79], v[16:23], v14
  v_exp_f32 v28, v28
  v_exp_f32 v29, v29
  v_exp_f32 v30, v30
  v_exp_f32 v31, v31
  ds_read_b128 v[76:79], v7 offset:19648
  s_cmp_eq_u32 s63, 0
  s_cbranch_scc0 P2_U01
  buffer_store_dwordx4 v[180:183], v1, s[8:11], s74 offen offset:1024 sc1
P2_U01:
  s_add_u32 s28, s60, 8192
  s_add_u32 m0, s28, s59
  s_add_u32 s28, s28, s58
  buffer_load_dwordx4 v1, s[8:11], s28 offen sc1 lds
  s_setprio 1
  s_waitcnt lgkmcnt(3)
  v_smfmac_f32_32x32x32_bf16 v[48:63], v[80:83], v[24:31], v14
  ds_read_b128 v[80:83], v7 offset:20256
  v_exp_f32 v32, v32
  v_exp_f32 v33, v33
  v_exp_f32 v34, v34
  v_exp_f32 v35, v35
  s_waitcnt lgkmcnt(2)
  v_mfma_f32_32x32x16_bf16 v[16:31], v[64:67], v[8:11], 0
  v_exp_f32 v36, v36
  v_exp_f32 v37, v37
  v_exp_f32 v38, v38
  v_exp_f32 v39, v39
  v_mfma_f32_32x32x8_bf16 v[16:31], v[72:73], v[12:13], v[16:31]
  ds_read_b128 v[68:71], v5 offset:3072
  ds_read_b32 v74, v6 offset:16768
  v_exp_f32 v40, v40
  v_exp_f32 v41, v41
  v_exp_f32 v42, v42
  v_exp_f32 v43, v43
  s_waitcnt lgkmcnt(3)
  v_smfmac_f32_32x32x32_bf16 v[48:63], v[76:79], v[32:39], v14
  v_exp_f32 v44, v44
  v_exp_f32 v45, v45
  v_exp_f32 v46, v46
  v_exp_f32 v47, v47
  ds_read_b128 v[76:79], v7 offset:20864
  s_cmp_eq_u32 s63, 0
  s_cbranch_scc0 P2_U02
  buffer_store_dwordx4 v[184:187], v1, s[8:11], s75 offen sc1
P2_U02:
  s_add_u32 s28, s60, 16384
  s_add_u32 m0, s28, s59
  s_add_u32 s28, s28, s58
  buffer_load_dwordx4 v1, s[8:11], s28 offen sc1 lds
  s_setprio 0
  s_waitcnt lgkmcnt(3)
  v_smfmac_f32_32x32x32_bf16 v[48:63], v[80:83], v[40:47], v14
  ds_read_b128 v[80:83], v7 offset:21472
  v_exp_f32 v16, v16
  v_exp_f32 v17, v17
  v_exp_f32 v18, v18
  v_exp_f32 v19, v19
  s_waitcnt lgkmcnt(2)
  v_mfma_f32_32x32x16_bf16 v[32:47], v[68:71], v[8:11], 0
  v_exp_f32 v20, v20
  v_exp_f32 v21, v21
  v_exp_f32 v22, v22
  v_exp_f32 v23, v23
  v_mfma_f32_32x32x8_bf16 v[32:47], v[74:75], v[12:13], v[32:47]
  ds_read_b128 v[64:67], v5 offset:4096
  ds_read_b32 v72, v6 offset:16896
  v_exp_f32 v24, v24
  v_exp_f32 v25, v25
  v_exp_f32 v26, v26
  v_exp_f32 v27, v27
  s_waitcnt lgkmcnt(3)
  v_smfmac_f32_32x32x32_bf16 v[48:63], v[76:79], v[16:23], v14
  v_exp_f32 v28, v28
  v_exp_f32 v29, v29
  v_exp_f32 v30, v30
  v_exp_f32 v31, v31
  ds_read_b128 v[76:79], v7 offset:22080
  s_cmp_eq_u32 s63, 0
  s_cbranch_scc0 P2_U03
  buffer_store_dword v206, v200, s[8:11], s75 offen offset:1024 sc1
P2_U03:
  s_add_u32 s28, s60, 24576
  s_add_u32 m0, s28, s59
  s_add_u32 s28, s28, s58
  buffer_load_dwordx4 v1, s[8:11], s28 offen sc1 lds
  s_setprio 1
  s_waitcnt lgkmcnt(3)
  v_smfmac_f32_32x32x32_bf16 v[48:63], v[80:83], v[24:31], v14
  ds_read_b128 v[80:83], v7 offset:22688
  v_exp_f32 v32, v32
  v_exp_f32 v33, v33
  v_exp_f32 v34, v34
  v_exp_f32 v35, v35
  s_waitcnt lgkmcnt(2)
  v_mfma_f32_32x32x16_bf16 v[16:31], v[64:67], v[8:11], 0
  v_exp_f32 v36, v36
  v_exp_f32 v37, v37
  v_exp_f32 v38, v38
  v_exp_f32 v39, v39
  v_mfma_f32_32x32x8_bf16 v[16:31], v[72:73], v[12:13], v[16:31]
  ds_read_b128 v[68:71], v5 offset:5120
  ds_read_b32 v74, v6 offset:17024
  v_exp_f32 v40, v40
  v_exp_f32 v41, v41
  v_exp_f32 v42, v42
  v_exp_f32 v43, v43
  s_waitcnt lgkmcnt(3)
  v_smfmac_f32_32x32x32_bf16 v[48:63], v[76:79], v[32:39], v14
  v_exp_f32 v44, v44
  v_exp_f32 v45, v45
  v_exp_f32 v46, v46
  v_exp_f32 v47, v47
  ds_read_b128 v[76:79], v7 offset:23296
  s_cmp_eq_u32 s63, 0
  s_cbranch_scc0 P2_U04
  s_add_u32 s75, s75, 73728
  buffer_store_dwordx4 v[188:191], v1, s[8:11], s75 offen sc1
P2_U04:
  s_mov_b32 s28, s61
  s_add_u32 m0, s28, s59
  s_add_u32 s28, s28, s58
  buffer_load_dwordx4 v1, s[8:11], s28 offen sc1 lds
  s_add_u32 s58, s58, 37888
  s_add_u32 s59, s59, 37888
  s_setprio 0
  s_waitcnt lgkmcnt(3)
  v_smfmac_f32_32x32x32_bf16 v[48:63], v[80:83], v[40:47], v14
  ds_read_b128 v[80:83], v7 offset:23904
  v_exp_f32 v16, v16
  v_exp_f32 v17, v17
  v_exp_f32 v18, v18
  v_exp_f32 v19, v19
  s_waitcnt lgkmcnt(2)
  v_mfma_f32_32x32x16_bf16 v[32:47], v[68:71], v[8:11], 0
  v_exp_f32 v20, v20
  v_exp_f32 v21, v21
  v_exp_f32 v22, v22
  v_exp_f32 v23, v23
  v_mfma_f32_32x32x8_bf16 v[32:47], v[74:75], v[12:13], v[32:47]
  ds_read_b128 v[64:67], v5 offset:6144
  ds_read_b32 v72, v6 offset:17152
  v_exp_f32 v24, v24
  v_exp_f32 v25, v25
  v_exp_f32 v26, v26
  v_exp_f32 v27, v27
  s_waitcnt lgkmcnt(3)
  v_smfmac_f32_32x32x32_bf16 v[48:63], v[76:79], v[16:23], v14
  v_exp_f32 v28, v28
  v_exp_f32 v29, v29
  v_exp_f32 v30, v30
  v_exp_f32 v31, v31
  ds_read_b128 v[76:79], v7 offset:24512
  s_cmp_eq_u32 s63, 0
  s_cbranch_scc0 P2_U05
  buffer_store_dword v207, v200, s[8:11], s75 offen offset:1024 sc1
P2_U05:
  s_setprio 1
  s_waitcnt lgkmcnt(3)
  v_smfmac_f32_32x32x32_bf16 v[48:63], v[80:83], v[24:31], v14
  ds_read_b128 v[80:83], v7 offset:25120
  v_exp_f32 v32, v32
  v_exp_f32 v33, v33
  v_exp_f32 v34, v34
  v_exp_f32 v35, v35
  s_waitcnt lgkmcnt(2)
  v_mfma_f32_32x32x16_bf16 v[16:31], v[64:67], v[8:11], 0
  v_exp_f32 v36, v36
  v_exp_f32 v37, v37
  v_exp_f32 v38, v38
  v_exp_f32 v39, v39
  v_mfma_f32_32x32x8_bf16 v[16:31], v[72:73], v[12:13], v[16:31]
  ds_read_b128 v[68:71], v5 offset:7168
  ds_read_b32 v74, v6 offset:17280
  v_exp_f32 v40, v40
  v_exp_f32 v41, v41
  v_exp_f32 v42, v42
  v_exp_f32 v43, v43
  s_waitcnt lgkmcnt(3)
  v_smfmac_f32_32x32x32_bf16 v[48:63], v[76:79], v[32:39], v14
  v_exp_f32 v44, v44
  v_exp_f32 v45, v45
  v_exp_f32 v46, v46
  v_exp_f32 v47, v47
  ds_read_b128 v[76:79], v7 offset:25728
  s_cmp_eq_u32 s63, 0
  s_cbranch_scc0 P2_U06
  s_add_u32 s75, s75, 73728
  buffer_store_dwordx4 v[192:195], v1, s[8:11], s75 offen sc1
P2_U06:
  s_setprio 0
  s_waitcnt lgkmcnt(3)
  v_smfmac_f32_32x32x32_bf16 v[48:63], v[80:83], v[40:47], v14
  ds_read_b128 v[80:83], v7 offset:26336
  v_exp_f32 v16, v16
  v_exp_f32 v17, v17
  v_exp_f32 v18, v18
  v_exp_f32 v19, v19
  s_waitcnt lgkmcnt(2)
  v_mfma_f32_32x32x16_bf16 v[32:47], v[68:71], v[8:11], 0
  v_exp_f32 v20, v20
  v_exp_f32 v21, v21
  v_exp_f32 v22, v22
  v_exp_f32 v23, v23
  v_mfma_f32_32x32x8_bf16 v[32:47], v[74:75], v[12:13], v[32:47]
  ds_read_b128 v[64:67], v5 offset:8192
  ds_read_b32 v72, v6 offset:17408
  v_exp_f32 v24, v24
  v_exp_f32 v25, v25
  v_exp_f32 v26, v26
  v_exp_f32 v27, v27
  s_waitcnt lgkmcnt(3)
  v_smfmac_f32_32x32x32_bf16 v[48:63], v[76:79], v[16:23], v14
  v_exp_f32 v28, v28
  v_exp_f32 v29, v29
  v_exp_f32 v30, v30
  v_exp_f32 v31, v31
  ds_read_b128 v[76:79], v7 offset:26944
  s_cmp_eq_u32 s63, 0
  s_cbranch_scc0 P2_U07
  s_add_u32 s75, s75, 73728
  buffer_store_dwordx4 v[196:199], v1, s[8:11], s75 offen sc1
P2_U07:
  s_setprio 1
  s_waitcnt lgkmcnt(3)
  v_smfmac_f32_32x32x32_bf16 v[48:63], v[80:83], v[24:31], v14
  ds_read_b128 v[80:83], v7 offset:27552
  v_exp_f32 v32, v32
  v_exp_f32 v33, v33
  v_exp_f32 v34, v34
  v_exp_f32 v35, v35
  s_waitcnt lgkmcnt(2)
  v_mfma_f32_32x32x16_bf16 v[16:31], v[64:67], v[8:11], 0
  v_exp_f32 v36, v36
  v_exp_f32 v37, v37
  v_exp_f32 v38, v38
  v_exp_f32 v39, v39
  v_mfma_f32_32x32x8_bf16 v[16:31], v[72:73], v[12:13], v[16:31]
  ds_read_b128 v[68:71], v5 offset:9216
  ds_read_b32 v74, v6 offset:17536
  v_exp_f32 v40, v40
  v_exp_f32 v41, v41
  v_exp_f32 v42, v42
  v_exp_f32 v43, v43
  s_waitcnt lgkmcnt(3)
  v_smfmac_f32_32x32x32_bf16 v[48:63], v[76:79], v[32:39], v14
  v_exp_f32 v44, v44
  v_exp_f32 v45, v45
  v_exp_f32 v46, v46
  v_exp_f32 v47, v47
  ds_read_b128 v[76:79], v7 offset:28160
  s_setprio 0
  s_waitcnt lgkmcnt(3)
  v_smfmac_f32_32x32x32_bf16 v[48:63], v[80:83], v[40:47], v14
  ds_read_b128 v[80:83], v7 offset:28768
  v_exp_f32 v16, v16
  v_exp_f32 v17, v17
  v_exp_f32 v18, v18
  v_exp_f32 v19, v19
  s_waitcnt lgkmcnt(2)
  v_mfma_f32_32x32x16_bf16 v[32:47], v[68:71], v[8:11], 0
  v_exp_f32 v20, v20
  v_exp_f32 v21, v21
  v_exp_f32 v22, v22
  v_exp_f32 v23, v23
  v_mfma_f32_32x32x8_bf16 v[32:47], v[74:75], v[12:13], v[32:47]
  ds_read_b128 v[64:67], v5 offset:10240
  ds_read_b32 v72, v6 offset:17664
  v_exp_f32 v24, v24
  v_exp_f32 v25, v25
  v_exp_f32 v26, v26
  v_exp_f32 v27, v27
  s_waitcnt lgkmcnt(3)
  v_smfmac_f32_32x32x32_bf16 v[48:63], v[76:79], v[16:23], v14
  v_exp_f32 v28, v28
  v_exp_f32 v29, v29
  v_exp_f32 v30, v30
  v_exp_f32 v31, v31
  ds_read_b128 v[76:79], v7 offset:29376
  s_setprio 1
  s_waitcnt lgkmcnt(3)
  v_smfmac_f32_32x32x32_bf16 v[48:63], v[80:83], v[24:31], v14
  ds_read_b128 v[80:83], v7 offset:29984
  v_exp_f32 v32, v32
  v_exp_f32 v33, v33
  v_exp_f32 v34, v34
  v_exp_f32 v35, v35
  s_waitcnt lgkmcnt(2)
  v_mfma_f32_32x32x16_bf16 v[16:31], v[64:67], v[8:11], 0
  v_exp_f32 v36, v36
  v_exp_f32 v37, v37
  v_exp_f32 v38, v38
  v_exp_f32 v39, v39
  v_mfma_f32_32x32x8_bf16 v[16:31], v[72:73], v[12:13], v[16:31]
  ds_read_b128 v[68:71], v5 offset:11264
  ds_read_b32 v74, v6 offset:17792
  v_exp_f32 v40, v40
  v_exp_f32 v41, v41
  v_exp_f32 v42, v42
  v_exp_f32 v43, v43
  s_waitcnt lgkmcnt(3)
  v_smfmac_f32_32x32x32_bf16 v[48:63], v[76:79], v[32:39], v14
  v_exp_f32 v44, v44
  v_exp_f32 v45, v45
  v_exp_f32 v46, v46
  v_exp_f32 v47, v47
  ds_read_b128 v[76:79], v7 offset:30592
  s_setprio 0
  s_waitcnt lgkmcnt(3)
  v_smfmac_f32_32x32x32_bf16 v[48:63], v[80:83], v[40:47], v14
  ds_read_b128 v[80:83], v7 offset:31200
  v_exp_f32 v16, v16
  v_exp_f32 v17, v17
  v_exp_f32 v18, v18
  v_exp_f32 v19, v19
  s_waitcnt lgkmcnt(2)
  v_mfma_f32_32x32x16_bf16 v[32:47], v[68:71], v[8:11], 0
  v_exp_f32 v20, v20
  v_exp_f32 v21, v21
  v_exp_f32 v22, v22
  v_exp_f32 v23, v23
  v_mfma_f32_32x32x8_bf16 v[32:47], v[74:75], v[12:13], v[32:47]
  ds_read_b128 v[64:67], v5 offset:12288
  ds_read_b32 v72, v6 offset:17920
  v_exp_f32 v24, v24
  v_exp_f32 v25, v25
  v_exp_f32 v26, v26
  v_exp_f32 v27, v27
  s_waitcnt lgkmcnt(3)
  v_smfmac_f32_32x32x32_bf16 v[48:63], v[76:79], v[16:23], v14
  v_exp_f32 v28, v28
  v_exp_f32 v29, v29
  v_exp_f32 v30, v30
  v_exp_f32 v31, v31
  ds_read_b128 v[76:79], v7 offset:31808
  s_setprio 1
  s_waitcnt lgkmcnt(3)
  v_smfmac_f32_32x32x32_bf16 v[48:63], v[80:83], v[24:31], v14
  ds_read_b128 v[80:83], v7 offset:32416
  v_exp_f32 v32, v32
  v_exp_f32 v33, v33
  v_exp_f32 v34, v34
  v_exp_f32 v35, v35
  s_waitcnt lgkmcnt(2)
  v_mfma_f32_32x32x16_bf16 v[16:31], v[64:67], v[8:11], 0
  v_exp_f32 v36, v36
  v_exp_f32 v37, v37
  v_exp_f32 v38, v38
  v_exp_f32 v39, v39
  v_mfma_f32_32x32x8_bf16 v[16:31], v[72:73], v[12:13], v[16:31]
  ds_read_b128 v[68:71], v5 offset:13312
  ds_read_b32 v74, v6 offset:18048
  v_exp_f32 v40, v40
  v_exp_f32 v41, v41
  v_exp_f32 v42, v42
  v_exp_f32 v43, v43
  s_waitcnt lgkmcnt(3)
  v_smfmac_f32_32x32x32_bf16 v[48:63], v[76:79], v[32:39], v14
  v_exp_f32 v44, v44
  v_exp_f32 v45, v45
  v_exp_f32 v46, v46
  v_exp_f32 v47, v47
  ds_read_b128 v[76:79], v7 offset:33024
  s_setprio 0
  s_waitcnt lgkmcnt(3)
  v_smfmac_f32_32x32x32_bf16 v[48:63], v[80:83], v[40:47], v14
  ds_read_b128 v[80:83], v7 offset:33632
  v_exp_f32 v16, v16
  v_exp_f32 v17, v17
  v_exp_f32 v18, v18
  v_exp_f32 v19, v19
  s_waitcnt lgkmcnt(2)
  v_mfma_f32_32x32x16_bf16 v[32:47], v[68:71], v[8:11], 0
  v_exp_f32 v20, v20
  v_exp_f32 v21, v21
  v_exp_f32 v22, v22
  v_exp_f32 v23, v23
  v_mfma_f32_32x32x8_bf16 v[32:47], v[74:75], v[12:13], v[32:47]
  ds_read_b128 v[64:67], v5 offset:14336
  ds_read_b32 v72, v6 offset:18176
  v_exp_f32 v24, v24
  v_exp_f32 v25, v25
  v_exp_f32 v26, v26
  v_exp_f32 v27, v27
  s_waitcnt lgkmcnt(3)
  v_smfmac_f32_32x32x32_bf16 v[48:63], v[76:79], v[16:23], v14
  v_exp_f32 v28, v28
  v_exp_f32 v29, v29
  v_exp_f32 v30, v30
  v_exp_f32 v31, v31
  ds_read_b128 v[76:79], v7 offset:34240
  s_setprio 1
  s_waitcnt lgkmcnt(3)
  v_smfmac_f32_32x32x32_bf16 v[48:63], v[80:83], v[24:31], v14
  ds_read_b128 v[80:83], v7 offset:34848
  v_exp_f32 v32, v32
  v_exp_f32 v33, v33
  v_exp_f32 v34, v34
  v_exp_f32 v35, v35
  s_waitcnt lgkmcnt(2)
  v_mfma_f32_32x32x16_bf16 v[16:31], v[64:67], v[8:11], 0
  v_exp_f32 v36, v36
  v_exp_f32 v37, v37
  v_exp_f32 v38, v38
  v_exp_f32 v39, v39
  v_mfma_f32_32x32x8_bf16 v[16:31], v[72:73], v[12:13], v[16:31]
  ds_read_b128 v[68:71], v5 offset:15360
  ds_read_b32 v74, v6 offset:18304
  v_exp_f32 v40, v40
  v_exp_f32 v41, v41
  v_exp_f32 v42, v42
  v_exp_f32 v43, v43
  s_waitcnt lgkmcnt(3)
  v_smfmac_f32_32x32x32_bf16 v[48:63], v[76:79], v[32:39], v14
  v_exp_f32 v44, v44
  v_exp_f32 v45, v45
  v_exp_f32 v46, v46
  v_exp_f32 v47, v47
  ds_read_b128 v[76:79], v7 offset:35456
  s_waitcnt vmcnt(0)
  s_barrier
  s_cmp_eq_u32 s73, 0
  s_cbranch_scc0 P2_U1
  s_lshl_b32 s28, s24, 14
  s_lshl_b32 s29, s26, 11
  s_add_u32 s28, s28, s29
  s_lshl_b32 s29, s25, 7
  s_add_u32 s28, s28, s29
  s_add_u32 s28, s28, 17825792
  s_mov_b64 exec, 1
  v_mov_b32 v106, 0
  v_mov_b32 v107, 1
  buffer_store_dword v107, v106, s[8:11], s28 offen sc1
  s_mov_b64 exec, -1
P2_U1:
  s_setprio 0
  s_waitcnt lgkmcnt(3)
  v_smfmac_f32_32x32x32_bf16 v[48:63], v[80:83], v[40:47], v14
  ds_read_b128 v[80:83], v7 offset:36064
  v_exp_f32 v16, v16
  v_exp_f32 v17, v17
  v_exp_f32 v18, v18
  v_exp_f32 v19, v19
  s_waitcnt lgkmcnt(2)
  v_mfma_f32_32x32x16_bf16 v[32:47], v[68:71], v[8:11], 0
  v_exp_f32 v20, v20
  v_exp_f32 v21, v21
  v_exp_f32 v22, v22
  v_exp_f32 v23, v23
  v_mfma_f32_32x32x8_bf16 v[32:47], v[74:75], v[12:13], v[32:47]
  ds_read_b128 v[64:67], v5 offset:37888
  ds_read_b32 v72, v6 offset:54272
  v_exp_f32 v24, v24
  v_exp_f32 v25, v25
  v_exp_f32 v26, v26
  v_exp_f32 v27, v27
  s_waitcnt lgkmcnt(3)
  v_smfmac_f32_32x32x32_bf16 v[48:63], v[76:79], v[16:23], v14
  v_exp_f32 v28, v28
  v_exp_f32 v29, v29
  v_exp_f32 v30, v30
  v_exp_f32 v31, v31
  ds_read_b128 v[76:79], v7 offset:36672
  s_setprio 1
  s_waitcnt lgkmcnt(3)
  v_smfmac_f32_32x32x32_bf16 v[48:63], v[80:83], v[24:31], v14
  ds_read_b128 v[80:83], v7 offset:37280
  v_exp_f32 v32, v32
  v_exp_f32 v33, v33
  v_exp_f32 v34, v34
  v_exp_f32 v35, v35
  s_waitcnt lgkmcnt(2)
  v_mfma_f32_32x32x16_bf16 v[16:31], v[64:67], v[8:11], 0
  v_exp_f32 v36, v36
  v_exp_f32 v37, v37
  v_exp_f32 v38, v38
  v_exp_f32 v39, v39
  v_mfma_f32_32x32x8_bf16 v[16:31], v[72:73], v[12:13], v[16:31]
  ds_read_b128 v[68:71], v5 offset:38912
  ds_read_b32 v74, v6 offset:54400
  v_exp_f32 v40, v40
  v_exp_f32 v41, v41
  v_exp_f32 v42, v42
  v_exp_f32 v43, v43
  s_waitcnt lgkmcnt(3)
  v_smfmac_f32_32x32x32_bf16 v[48:63], v[76:79], v[32:39], v14
  v_exp_f32 v44, v44
  v_exp_f32 v45, v45
  v_exp_f32 v46, v46
  v_exp_f32 v47, v47
  ds_read_b128 v[76:79], v7 offset:56320
  v_add_u32 v5, 37888, v5
  v_add_u32 v6, 37888, v6
  v_add_u32 v7, 37888, v7
  s_add_u32 s28, s60, 0
  s_add_u32 m0, s28, s59
  s_add_u32 s28, s28, s58
  buffer_load_dwordx4 v1, s[8:11], s28 offen sc1 lds
  s_setprio 0
  s_waitcnt lgkmcnt(3)
  v_smfmac_f32_32x32x32_bf16 v[48:63], v[80:83], v[40:47], v14
  ds_read_b128 v[80:83], v7 offset:19040
  v_exp_f32 v16, v16
  v_exp_f32 v17, v17
  v_exp_f32 v18, v18
  v_exp_f32 v19, v19
  s_waitcnt lgkmcnt(2)
  v_mfma_f32_32x32x16_bf16 v[32:47], v[68:71], v[8:11], 0
  v_exp_f32 v20, v20
  v_exp_f32 v21, v21
  v_exp_f32 v22, v22
  v_exp_f32 v23, v23
  v_mfma_f32_32x32x8_bf16 v[32:47], v[74:75], v[12:13], v[32:47]
  ds_read_b128 v[64:67], v5 offset:2048
  ds_read_b32 v72, v6 offset:16640
  v_exp_f32 v24, v24
  v_exp_f32 v25, v25
  v_exp_f32 v26, v26
  v_exp_f32 v27, v27
  s_waitcnt lgkmcnt(3)
  v_smfmac_f32_32x32x32_bf16 v[48:63], v[76:79], v[16:23], v14
  v_exp_f32 v28, v28
  v_exp_f32 v29, v29
  v_exp_f32 v30, v30
  v_exp_f32 v31, v31
  ds_read_b128 v[76:79], v7 offset:19648
  s_add_u32 s28, s60, 8192
  s_add_u32 m0, s28, s59
  s_add_u32 s28, s28, s58
  buffer_load_dwordx4 v1, s[8:11], s28 offen sc1 lds
  s_setprio 1
  s_waitcnt lgkmcnt(3)
  v_smfmac_f32_32x32x32_bf16 v[48:63], v[80:83], v[24:31], v14
  ds_read_b128 v[80:83], v7 offset:20256
  v_exp_f32 v32, v32
  v_exp_f32 v33, v33
  v_exp_f32 v34, v34
  v_exp_f32 v35, v35
  s_waitcnt lgkmcnt(2)
  v_mfma_f32_32x32x16_bf16 v[16:31], v[64:67], v[8:11], 0
  v_exp_f32 v36, v36
  v_exp_f32 v37, v37
  v_exp_f32 v38, v38
  v_exp_f32 v39, v39
  v_mfma_f32_32x32x8_bf16 v[16:31], v[72:73], v[12:13], v[16:31]
  ds_read_b128 v[68:71], v5 offset:3072
  ds_read_b32 v74, v6 offset:16768
  v_exp_f32 v40, v40
  v_exp_f32 v41, v41
  v_exp_f32 v42, v42
  v_exp_f32 v43, v43
  s_waitcnt lgkmcnt(3)
  v_smfmac_f32_32x32x32_bf16 v[48:63], v[76:79], v[32:39], v14
  v_exp_f32 v44, v44
  v_exp_f32 v45, v45
  v_exp_f32 v46, v46
  v_exp_f32 v47, v47
  ds_read_b128 v[76:79], v7 offset:20864
  s_add_u32 s28, s60, 16384
  s_add_u32 m0, s28, s59
  s_add_u32 s28, s28, s58
  buffer_load_dwordx4 v1, s[8:11], s28 offen sc1 lds
  s_setprio 0
  s_waitcnt lgkmcnt(3)
  v_smfmac_f32_32x32x32_bf16 v[48:63], v[80:83], v[40:47], v14
  ds_read_b128 v[80:83], v7 offset:21472
  v_exp_f32 v16, v16
  v_exp_f32 v17, v17
  v_exp_f32 v18, v18
  v_exp_f32 v19, v19
  s_waitcnt lgkmcnt(2)
  v_mfma_f32_32x32x16_bf16 v[32:47], v[68:71], v[8:11], 0
  v_exp_f32 v20, v20
  v_exp_f32 v21, v21
  v_exp_f32 v22, v22
  v_exp_f32 v23, v23
  v_mfma_f32_32x32x8_bf16 v[32:47], v[74:75], v[12:13], v[32:47]
  ds_read_b128 v[64:67], v5 offset:4096
  ds_read_b32 v72, v6 offset:16896
  v_exp_f32 v24, v24
  v_exp_f32 v25, v25
  v_exp_f32 v26, v26
  v_exp_f32 v27, v27
  s_waitcnt lgkmcnt(3)
  v_smfmac_f32_32x32x32_bf16 v[48:63], v[76:79], v[16:23], v14
  v_exp_f32 v28, v28
  v_exp_f32 v29, v29
  v_exp_f32 v30, v30
  v_exp_f32 v31, v31
  ds_read_b128 v[76:79], v7 offset:22080
  s_add_u32 s28, s60, 24576
  s_add_u32 m0, s28, s59
  s_add_u32 s28, s28, s58
  buffer_load_dwordx4 v1, s[8:11], s28 offen sc1 lds
  s_and_b32 s28, s2, 7
  s_lshl_b32 s28, s28, 11
  s_add_u32 s28, s28, 17842176
  buffer_load_dword v126, v127, s[8:11], s28 offen sc1
  s_setprio 1
  s_waitcnt lgkmcnt(3)
  v_smfmac_f32_32x32x32_bf16 v[48:63], v[80:83], v[24:31], v14
  ds_read_b128 v[80:83], v7 offset:22688
  v_exp_f32 v32, v32
  v_exp_f32 v33, v33
  v_exp_f32 v34, v34
  v_exp_f32 v35, v35
  s_waitcnt lgkmcnt(2)
  v_mfma_f32_32x32x16_bf16 v[16:31], v[64:67], v[8:11], 0
  v_exp_f32 v36, v36
  v_exp_f32 v37, v37
  v_exp_f32 v38, v38
  v_exp_f32 v39, v39
  v_mfma_f32_32x32x8_bf16 v[16:31], v[72:73], v[12:13], v[16:31]
  ds_read_b128 v[68:71], v5 offset:5120
  ds_read_b32 v74, v6 offset:17024
  v_exp_f32 v40, v40
  v_exp_f32 v41, v41
  v_exp_f32 v42, v42
  v_exp_f32 v43, v43
  s_waitcnt lgkmcnt(3)
  v_smfmac_f32_32x32x32_bf16 v[48:63], v[76:79], v[32:39], v14
  v_exp_f32 v44, v44
  v_exp_f32 v45, v45
  v_exp_f32 v46, v46
  v_exp_f32 v47, v47
  ds_read_b128 v[76:79], v7 offset:23296
  s_mov_b32 s28, s61
  s_add_u32 m0, s28, s59
  s_add_u32 s28, s28, s58
  buffer_load_dwordx4 v1, s[8:11], s28 offen sc1 lds
  s_add_u32 s58, s58, 37888
  s_add_u32 s59, s59, 37888
  s_setprio 0
  s_waitcnt lgkmcnt(3)
  v_smfmac_f32_32x32x32_bf16 v[48:63], v[80:83], v[40:47], v14
  ds_read_b128 v[80:83], v7 offset:23904
  v_exp_f32 v16, v16
  v_exp_f32 v17, v17
  v_exp_f32 v18, v18
  v_exp_f32 v19, v19
  s_waitcnt lgkmcnt(2)
  v_mfma_f32_32x32x16_bf16 v[32:47], v[68:71], v[8:11], 0
  v_exp_f32 v20, v20
  v_exp_f32 v21, v21
  v_exp_f32 v22, v22
  v_exp_f32 v23, v23
  v_mfma_f32_32x32x8_bf16 v[32:47], v[74:75], v[12:13], v[32:47]
  ds_read_b128 v[64:67], v5 offset:6144
  ds_read_b32 v72, v6 offset:17152
  v_exp_f32 v24, v24
  v_exp_f32 v25, v25
  v_exp_f32 v26, v26
  v_exp_f32 v27, v27
  s_waitcnt lgkmcnt(3)
  v_smfmac_f32_32x32x32_bf16 v[48:63], v[76:79], v[16:23], v14
  v_exp_f32 v28, v28
  v_exp_f32 v29, v29
  v_exp_f32 v30, v30
  v_exp_f32 v31, v31
  ds_read_b128 v[76:79], v7 offset:24512
  s_setprio 1
  s_waitcnt lgkmcnt(3)
  v_smfmac_f32_32x32x32_bf16 v[48:63], v[80:83], v[24:31], v14
  ds_read_b128 v[80:83], v7 offset:25120
  v_exp_f32 v32, v32
  v_exp_f32 v33, v33
  v_exp_f32 v34, v34
  v_exp_f32 v35, v35
  s_waitcnt lgkmcnt(2)
  v_mfma_f32_32x32x16_bf16 v[16:31], v[64:67], v[8:11], 0
  v_exp_f32 v36, v36
  v_exp_f32 v37, v37
  v_exp_f32 v38, v38
  v_exp_f32 v39, v39
  v_mfma_f32_32x32x8_bf16 v[16:31], v[72:73], v[12:13], v[16:31]
  ds_read_b128 v[68:71], v5 offset:7168
  ds_read_b32 v74, v6 offset:17280
  v_exp_f32 v40, v40
  v_exp_f32 v41, v41
  v_exp_f32 v42, v42
  v_exp_f32 v43, v43
  s_waitcnt lgkmcnt(3)
  v_smfmac_f32_32x32x32_bf16 v[48:63], v[76:79], v[32:39], v14
  v_exp_f32 v44, v44
  v_exp_f32 v45, v45
  v_exp_f32 v46, v46
  v_exp_f32 v47, v47
  ds_read_b128 v[76:79], v7 offset:25728
  s_setprio 0
  s_waitcnt lgkmcnt(3)
  v_smfmac_f32_32x32x32_bf16 v[48:63], v[80:83], v[40:47], v14
  ds_read_b128 v[80:83], v7 offset:26336
  v_exp_f32 v16, v16
  v_exp_f32 v17, v17
  v_exp_f32 v18, v18
  v_exp_f32 v19, v19
  s_waitcnt lgkmcnt(2)
  v_mfma_f32_32x32x16_bf16 v[32:47], v[68:71], v[8:11], 0
  v_exp_f32 v20, v20
  v_exp_f32 v21, v21
  v_exp_f32 v22, v22
  v_exp_f32 v23, v23
  v_mfma_f32_32x32x8_bf16 v[32:47], v[74:75], v[12:13], v[32:47]
  ds_read_b128 v[64:67], v5 offset:8192
  ds_read_b32 v72, v6 offset:17408
  v_exp_f32 v24, v24
  v_exp_f32 v25, v25
  v_exp_f32 v26, v26
  v_exp_f32 v27, v27
  s_waitcnt lgkmcnt(3)
  v_smfmac_f32_32x32x32_bf16 v[48:63], v[76:79], v[16:23], v14
  v_exp_f32 v28, v28
  v_exp_f32 v29, v29
  v_exp_f32 v30, v30
  v_exp_f32 v31, v31
  ds_read_b128 v[76:79], v7 offset:26944
  s_setprio 1
  s_waitcnt lgkmcnt(3)
  v_smfmac_f32_32x32x32_bf16 v[48:63], v[80:83], v[24:31], v14
  ds_read_b128 v[80:83], v7 offset:27552
  v_exp_f32 v32, v32
  v_exp_f32 v33, v33
  v_exp_f32 v34, v34
  v_exp_f32 v35, v35
  s_waitcnt lgkmcnt(2)
  v_mfma_f32_32x32x16_bf16 v[16:31], v[64:67], v[8:11], 0
  v_exp_f32 v36, v36
  v_exp_f32 v37, v37
  v_exp_f32 v38, v38
  v_exp_f32 v39, v39
  v_mfma_f32_32x32x8_bf16 v[16:31], v[72:73], v[12:13], v[16:31]
  ds_read_b128 v[68:71], v5 offset:9216
  ds_read_b32 v74, v6 offset:17536
  v_exp_f32 v40, v40
  v_exp_f32 v41, v41
  v_exp_f32 v42, v42
  v_exp_f32 v43, v43
  s_waitcnt lgkmcnt(3)
  v_smfmac_f32_32x32x32_bf16 v[48:63], v[76:79], v[32:39], v14
  v_exp_f32 v44, v44
  v_exp_f32 v45, v45
  v_exp_f32 v46, v46
  v_exp_f32 v47, v47
  ds_read_b128 v[76:79], v7 offset:28160
  s_setprio 0
  s_waitcnt lgkmcnt(3)
  v_smfmac_f32_32x32x32_bf16 v[48:63], v[80:83], v[40:47], v14
  ds_read_b128 v[80:83], v7 offset:28768
  v_exp_f32 v16, v16
  v_exp_f32 v17, v17
  v_exp_f32 v18, v18
  v_exp_f32 v19, v19
  s_waitcnt lgkmcnt(2)
  v_mfma_f32_32x32x16_bf16 v[32:47], v[68:71], v[8:11], 0
  v_exp_f32 v20, v20
  v_exp_f32 v21, v21
  v_exp_f32 v22, v22
  v_exp_f32 v23, v23
  v_mfma_f32_32x32x8_bf16 v[32:47], v[74:75], v[12:13], v[32:47]
  ds_read_b128 v[64:67], v5 offset:10240
  ds_read_b32 v72, v6 offset:17664
  v_exp_f32 v24, v24
  v_exp_f32 v25, v25
  v_exp_f32 v26, v26
  v_exp_f32 v27, v27
  s_waitcnt lgkmcnt(3)
  v_smfmac_f32_32x32x32_bf16 v[48:63], v[76:79], v[16:23], v14
  v_exp_f32 v28, v28
  v_exp_f32 v29, v29
  v_exp_f32 v30, v30
  v_exp_f32 v31, v31
  ds_read_b128 v[76:79], v7 offset:29376
  s_setprio 1
  s_waitcnt lgkmcnt(3)
  v_smfmac_f32_32x32x32_bf16 v[48:63], v[80:83], v[24:31], v14
  ds_read_b128 v[80:83], v7 offset:29984
  v_exp_f32 v32, v32
  v_exp_f32 v33, v33
  v_exp_f32 v34, v34
  v_exp_f32 v35, v35
  s_waitcnt lgkmcnt(2)
  v_mfma_f32_32x32x16_bf16 v[16:31], v[64:67], v[8:11], 0
  v_exp_f32 v36, v36
  v_exp_f32 v37, v37
  v_exp_f32 v38, v38
  v_exp_f32 v39, v39
  v_mfma_f32_32x32x8_bf16 v[16:31], v[72:73], v[12:13], v[16:31]
  ds_read_b128 v[68:71], v5 offset:11264
  ds_read_b32 v74, v6 offset:17792
  v_exp_f32 v40, v40
  v_exp_f32 v41, v41
  v_exp_f32 v42, v42
  v_exp_f32 v43, v43
  s_waitcnt lgkmcnt(3)
  v_smfmac_f32_32x32x32_bf16 v[48:63], v[76:79], v[32:39], v14
  v_exp_f32 v44, v44
  v_exp_f32 v45, v45
  v_exp_f32 v46, v46
  v_exp_f32 v47, v47
  ds_read_b128 v[76:79], v7 offset:30592
  s_setprio 0
  s_waitcnt lgkmcnt(3)
  v_smfmac_f32_32x32x32_bf16 v[48:63], v[80:83], v[40:47], v14
  ds_read_b128 v[80:83], v7 offset:31200
  v_exp_f32 v16, v16
  v_exp_f32 v17, v17
  v_exp_f32 v18, v18
  v_exp_f32 v19, v19
  s_waitcnt lgkmcnt(2)
  v_mfma_f32_32x32x16_bf16 v[32:47], v[68:71], v[8:11], 0
  v_exp_f32 v20, v20
  v_exp_f32 v21, v21
  v_exp_f32 v22, v22
  v_exp_f32 v23, v23
  v_mfma_f32_32x32x8_bf16 v[32:47], v[74:75], v[12:13], v[32:47]
  ds_read_b128 v[64:67], v5 offset:12288
  ds_read_b32 v72, v6 offset:17920
  v_exp_f32 v24, v24
  v_exp_f32 v25, v25
  v_exp_f32 v26, v26
  v_exp_f32 v27, v27
  s_waitcnt lgkmcnt(3)
  v_smfmac_f32_32x32x32_bf16 v[48:63], v[76:79], v[16:23], v14
  v_exp_f32 v28, v28
  v_exp_f32 v29, v29
  v_exp_f32 v30, v30
  v_exp_f32 v31, v31
  ds_read_b128 v[76:79], v7 offset:31808
  s_setprio 1
  s_waitcnt lgkmcnt(3)
  v_smfmac_f32_32x32x32_bf16 v[48:63], v[80:83], v[24:31], v14
  ds_read_b128 v[80:83], v7 offset:32416
  v_exp_f32 v32, v32
  v_exp_f32 v33, v33
  v_exp_f32 v34, v34
  v_exp_f32 v35, v35
  s_waitcnt lgkmcnt(2)
  v_mfma_f32_32x32x16_bf16 v[16:31], v[64:67], v[8:11], 0
  v_exp_f32 v36, v36
  v_exp_f32 v37, v37
  v_exp_f32 v38, v38
  v_exp_f32 v39, v39
  v_mfma_f32_32x32x8_bf16 v[16:31], v[72:73], v[12:13], v[16:31]
  ds_read_b128 v[68:71], v5 offset:13312
  ds_read_b32 v74, v6 offset:18048
  v_exp_f32 v40, v40
  v_exp_f32 v41, v41
  v_exp_f32 v42, v42
  v_exp_f32 v43, v43
  s_waitcnt lgkmcnt(3)
  v_smfmac_f32_32x32x32_bf16 v[48:63], v[76:79], v[32:39], v14
  v_exp_f32 v44, v44
  v_exp_f32 v45, v45
  v_exp_f32 v46, v46
  v_exp_f32 v47, v47
  ds_read_b128 v[76:79], v7 offset:33024
  s_setprio 0
  s_waitcnt lgkmcnt(3)
  v_smfmac_f32_32x32x32_bf16 v[48:63], v[80:83], v[40:47], v14
  ds_read_b128 v[80:83], v7 offset:33632
  v_exp_f32 v16, v16
  v_exp_f32 v17, v17
  v_exp_f32 v18, v18
  v_exp_f32 v19, v19
  s_waitcnt lgkmcnt(2)
  v_mfma_f32_32x32x16_bf16 v[32:47], v[68:71], v[8:11], 0
  v_exp_f32 v20, v20
  v_exp_f32 v21, v21
  v_exp_f32 v22, v22
  v_exp_f32 v23, v23
  v_mfma_f32_32x32x8_bf16 v[32:47], v[74:75], v[12:13], v[32:47]
  ds_read_b128 v[64:67], v5 offset:14336
  ds_read_b32 v72, v6 offset:18176
  v_exp_f32 v24, v24
  v_exp_f32 v25, v25
  v_exp_f32 v26, v26
  v_exp_f32 v27, v27
  s_waitcnt lgkmcnt(3)
  v_smfmac_f32_32x32x32_bf16 v[48:63], v[76:79], v[16:23], v14
  v_exp_f32 v28, v28
  v_exp_f32 v29, v29
  v_exp_f32 v30, v30
  v_exp_f32 v31, v31
  ds_read_b128 v[76:79], v7 offset:34240
  s_setprio 1
  s_waitcnt lgkmcnt(3)
  v_smfmac_f32_32x32x32_bf16 v[48:63], v[80:83], v[24:31], v14
  ds_read_b128 v[80:83], v7 offset:34848
  v_exp_f32 v32, v32
  v_exp_f32 v33, v33
  v_exp_f32 v34, v34
  v_exp_f32 v35, v35
  s_waitcnt lgkmcnt(2)
  v_mfma_f32_32x32x16_bf16 v[16:31], v[64:67], v[8:11], 0
  v_exp_f32 v36, v36
  v_exp_f32 v37, v37
  v_exp_f32 v38, v38
  v_exp_f32 v39, v39
  v_mfma_f32_32x32x8_bf16 v[16:31], v[72:73], v[12:13], v[16:31]
  ds_read_b128 v[68:71], v5 offset:15360
  ds_read_b32 v74, v6 offset:18304
  v_exp_f32 v40, v40
  v_exp_f32 v41, v41
  v_exp_f32 v42, v42
  v_exp_f32 v43, v43
  s_waitcnt lgkmcnt(3)
  v_smfmac_f32_32x32x32_bf16 v[48:63], v[76:79], v[32:39], v14
  v_exp_f32 v44, v44
  v_exp_f32 v45, v45
  v_exp_f32 v46, v46
  v_exp_f32 v47, v47
  ds_read_b128 v[76:79], v7 offset:35456
  s_waitcnt vmcnt(0)
  v_cmp_ne_u32 vcc, 1, v126
  s_nop 3
  s_cmp_eq_u64 vcc, 0
  s_cbranch_scc0 P2_REPOLL
P2_I2:
  s_barrier
  s_setprio 0
  s_waitcnt lgkmcnt(3)
  v_smfmac_f32_32x32x32_bf16 v[48:63], v[80:83], v[40:47], v14
  ds_read_b128 v[80:83], v7 offset:36064
  v_exp_f32 v16, v16
  v_exp_f32 v17, v17
  v_exp_f32 v18, v18
  v_exp_f32 v19, v19
  s_waitcnt lgkmcnt(2)
  v_mfma_f32_32x32x16_bf16 v[32:47], v[68:71], v[8:11], 0
  v_exp_f32 v20, v20
  v_exp_f32 v21, v21
  v_exp_f32 v22, v22
  v_exp_f32 v23, v23
  v_mfma_f32_32x32x8_bf16 v[32:47], v[74:75], v[12:13], v[32:47]
  ds_read_b128 v[64:67], v5 offset:37888
  ds_read_b32 v72, v6 offset:54272
  v_exp_f32 v24, v24
  v_exp_f32 v25, v25
  v_exp_f32 v26, v26
  v_exp_f32 v27, v27
  s_waitcnt lgkmcnt(3)
  v_smfmac_f32_32x32x32_bf16 v[48:63], v[76:79], v[16:23], v14
  v_exp_f32 v28, v28
  v_exp_f32 v29, v29
  v_exp_f32 v30, v30
  v_exp_f32 v31, v31
  ds_read_b128 v[76:79], v7 offset:36672
  s_setprio 1
  s_waitcnt lgkmcnt(3)
  v_smfmac_f32_32x32x32_bf16 v[48:63], v[80:83], v[24:31], v14
  ds_read_b128 v[80:83], v7 offset:37280
  v_exp_f32 v32, v32
  v_exp_f32 v33, v33
  v_exp_f32 v34, v34
  v_exp_f32 v35, v35
  s_waitcnt lgkmcnt(2)
  v_mfma_f32_32x32x16_bf16 v[16:31], v[64:67], v[8:11], 0
  v_exp_f32 v36, v36
  v_exp_f32 v37, v37
  v_exp_f32 v38, v38
  v_exp_f32 v39, v39
  v_mfma_f32_32x32x8_bf16 v[16:31], v[72:73], v[12:13], v[16:31]
  ds_read_b128 v[68:71], v5 offset:38912
  ds_read_b32 v74, v6 offset:54400
  v_exp_f32 v40, v40
  v_exp_f32 v41, v41
  v_exp_f32 v42, v42
  v_exp_f32 v43, v43
  s_waitcnt lgkmcnt(3)
  v_smfmac_f32_32x32x32_bf16 v[48:63], v[76:79], v[32:39], v14
  v_exp_f32 v44, v44
  v_exp_f32 v45, v45
  v_exp_f32 v46, v46
  v_exp_f32 v47, v47
  ds_read_b128 v[76:79], v7 offset:56320
  v_add_u32 v5, 37888, v5
  v_add_u32 v6, 37888, v6
  v_add_u32 v7, 37888, v7
  s_add_u32 s28, s60, 0
  s_add_u32 m0, s28, s59
  s_add_u32 s28, s28, s58
  buffer_load_dwordx4 v1, s[8:11], s28 offen sc1 lds
  s_setprio 0
  s_waitcnt lgkmcnt(3)
  v_smfmac_f32_32x32x32_bf16 v[48:63], v[80:83], v[40:47], v14
  ds_read_b128 v[80:83], v7 offset:19040
  v_exp_f32 v16, v16
  v_exp_f32 v17, v17
  v_exp_f32 v18, v18
  v_exp_f32 v19, v19
  s_waitcnt lgkmcnt(2)
  v_mfma_f32_32x32x16_bf16 v[32:47], v[68:71], v[8:11], 0
  v_exp_f32 v20, v20
  v_exp_f32 v21, v21
  v_exp_f32 v22, v22
  v_exp_f32 v23, v23
  v_mfma_f32_32x32x8_bf16 v[32:47], v[74:75], v[12:13], v[32:47]
  ds_read_b128 v[64:67], v5 offset:2048
  ds_read_b32 v72, v6 offset:16640
  v_exp_f32 v24, v24
  v_exp_f32 v25, v25
  v_exp_f32 v26, v26
  v_exp_f32 v27, v27
  s_waitcnt lgkmcnt(3)
  v_smfmac_f32_32x32x32_bf16 v[48:63], v[76:79], v[16:23], v14
  v_exp_f32 v28, v28
  v_exp_f32 v29, v29
  v_exp_f32 v30, v30
  v_exp_f32 v31, v31
  ds_read_b128 v[76:79], v7 offset:19648
  s_add_u32 s28, s60, 8192
  s_add_u32 m0, s28, s59
  s_add_u32 s28, s28, s58
  buffer_load_dwordx4 v1, s[8:11], s28 offen sc1 lds
  s_add_u32 s28, s38, 7864320
  buffer_load_dwordx4 v[120:123], v1, s[8:11], s28 offen sc1
  s_setprio 1
  s_waitcnt lgkmcnt(3)
  v_smfmac_f32_32x32x32_bf16 v[48:63], v[80:83], v[24:31], v14
  ds_read_b128 v[80:83], v7 offset:20256
  v_exp_f32 v32, v32
  v_exp_f32 v33, v33
  v_exp_f32 v34, v34
  v_exp_f32 v35, v35
  s_waitcnt lgkmcnt(2)
  v_mfma_f32_32x32x16_bf16 v[16:31], v[64:67], v[8:11], 0
  v_exp_f32 v36, v36
  v_exp_f32 v37, v37
  v_exp_f32 v38, v38
  v_exp_f32 v39, v39
  v_mfma_f32_32x32x8_bf16 v[16:31], v[72:73], v[12:13], v[16:31]
  ds_read_b128 v[68:71], v5 offset:3072
  ds_read_b32 v74, v6 offset:16768
  v_exp_f32 v40, v40
  v_exp_f32 v41, v41
  v_exp_f32 v42, v42
  v_exp_f32 v43, v43
  s_waitcnt lgkmcnt(3)
  v_smfmac_f32_32x32x32_bf16 v[48:63], v[76:79], v[32:39], v14
  v_exp_f32 v44, v44
  v_exp_f32 v45, v45
  v_exp_f32 v46, v46
  v_exp_f32 v47, v47
  ds_read_b128 v[76:79], v7 offset:20864
  s_add_u32 s28, s60, 16384
  s_add_u32 m0, s28, s59
  s_add_u32 s28, s28, s58
  buffer_load_dwordx4 v1, s[8:11], s28 offen sc1 lds
  s_add_u32 s28, s38, 7864320
  buffer_load_dword v124, v3, s[8:11], s28 offen offset:1024 sc1
  s_setprio 0
  s_waitcnt lgkmcnt(3)
  v_smfmac_f32_32x32x32_bf16 v[48:63], v[80:83], v[40:47], v14
  ds_read_b128 v[80:83], v7 offset:21472
  v_exp_f32 v16, v16
  v_exp_f32 v17, v17
  v_exp_f32 v18, v18
  v_exp_f32 v19, v19
  s_waitcnt lgkmcnt(2)
  v_mfma_f32_32x32x16_bf16 v[32:47], v[68:71], v[8:11], 0
  v_exp_f32 v20, v20
  v_exp_f32 v21, v21
  v_exp_f32 v22, v22
  v_exp_f32 v23, v23
  v_mfma_f32_32x32x8_bf16 v[32:47], v[74:75], v[12:13], v[32:47]
  ds_read_b128 v[64:67], v5 offset:4096
  ds_read_b32 v72, v6 offset:16896
  v_exp_f32 v24, v24
  v_exp_f32 v25, v25
  v_exp_f32 v26, v26
  v_exp_f32 v27, v27
  s_waitcnt lgkmcnt(3)
  v_smfmac_f32_32x32x32_bf16 v[48:63], v[76:79], v[16:23], v14
  v_exp_f32 v28, v28
  v_exp_f32 v29, v29
  v_exp_f32 v30, v30
  v_exp_f32 v31, v31
  ds_read_b128 v[76:79], v7 offset:22080
  s_add_u32 s28, s60, 24576
  s_add_u32 m0, s28, s59
  s_add_u32 s28, s28, s58
  buffer_load_dwordx4 v1, s[8:11], s28 offen sc1 lds
  s_mul_i32 s74, s32, 32768
  s_lshl_b32 s29, s3, 8
  s_add_u32 s74, s74, s29
  s_add_u32 s74, s74, 10485760
  buffer_load_dwordx4 v[84:87], v144, s[8:11], s74 offen sc1
  s_setprio 1
  s_waitcnt lgkmcnt(3)
  v_smfmac_f32_32x32x32_bf16 v[48:63], v[80:83], v[24:31], v14
  ds_read_b128 v[80:83], v7 offset:22688
  v_exp_f32 v32, v32
  v_exp_f32 v33, v33
  v_exp_f32 v34, v34
  v_exp_f32 v35, v35
  s_waitcnt lgkmcnt(2)
  v_mfma_f32_32x32x16_bf16 v[16:31], v[64:67], v[8:11], 0
  v_exp_f32 v36, v36
  v_exp_f32 v37, v37
  v_exp_f32 v38, v38
  v_exp_f32 v39, v39
  v_mfma_f32_32x32x8_bf16 v[16:31], v[72:73], v[12:13], v[16:31]
  ds_read_b128 v[68:71], v5 offset:5120
  ds_read_b32 v74, v6 offset:17024
  v_exp_f32 v40, v40
  v_exp_f32 v41, v41
  v_exp_f32 v42, v42
  v_exp_f32 v43, v43
  s_waitcnt lgkmcnt(3)
  v_smfmac_f32_32x32x32_bf16 v[48:63], v[76:79], v[32:39], v14
  v_exp_f32 v44, v44
  v_exp_f32 v45, v45
  v_exp_f32 v46, v46
  v_exp_f32 v47, v47
  ds_read_b128 v[76:79], v7 offset:23296
  s_mov_b32 s28, s61
  s_add_u32 m0, s28, s59
  s_add_u32 s28, s28, s58
  buffer_load_dwordx4 v1, s[8:11], s28 offen sc1 lds
  s_add_u32 s58, s58, 37888
  s_add_u32 s59, s59, 37888
  s_add_u32 s74, s74, 2048
  buffer_load_dwordx4 v[88:91], v144, s[8:11], s74 offen sc1
  s_setprio 0
  s_waitcnt lgkmcnt(3)
  v_smfmac_f32_32x32x32_bf16 v[48:63], v[80:83], v[40:47], v14
  ds_read_b128 v[80:83], v7 offset:23904
  v_exp_f32 v16, v16
  v_exp_f32 v17, v17
  v_exp_f32 v18, v18
  v_exp_f32 v19, v19
  s_waitcnt lgkmcnt(2)
  v_mfma_f32_32x32x16_bf16 v[32:47], v[68:71], v[8:11], 0
  v_exp_f32 v20, v20
  v_exp_f32 v21, v21
  v_exp_f32 v22, v22
  v_exp_f32 v23, v23
  v_mfma_f32_32x32x8_bf16 v[32:47], v[74:75], v[12:13], v[32:47]
  ds_read_b128 v[64:67], v5 offset:6144
  ds_read_b32 v72, v6 offset:17152
  v_exp_f32 v24, v24
  v_exp_f32 v25, v25
  v_exp_f32 v26, v26
  v_exp_f32 v27, v27
  s_waitcnt lgkmcnt(3)
  v_smfmac_f32_32x32x32_bf16 v[48:63], v[76:79], v[16:23], v14
  v_exp_f32 v28, v28
  v_exp_f32 v29, v29
  v_exp_f32 v30, v30
  v_exp_f32 v31, v31
  ds_read_b128 v[76:79], v7 offset:24512
  s_add_u32 s74, s74, 2048
  buffer_load_dwordx4 v[92:95], v144, s[8:11], s74 offen sc1
  s_setprio 1
  s_waitcnt lgkmcnt(3)
  v_smfmac_f32_32x32x32_bf16 v[48:63], v[80:83], v[24:31], v14
  ds_read_b128 v[80:83], v7 offset:25120
  v_exp_f32 v32, v32
  v_exp_f32 v33, v33
  v_exp_f32 v34, v34
  v_exp_f32 v35, v35
  s_waitcnt lgkmcnt(2)
  v_mfma_f32_32x32x16_bf16 v[16:31], v[64:67], v[8:11], 0
  v_exp_f32 v36, v36
  v_exp_f32 v37, v37
  v_exp_f32 v38, v38
  v_exp_f32 v39, v39
  v_mfma_f32_32x32x8_bf16 v[16:31], v[72:73], v[12:13], v[16:31]
  ds_read_b128 v[68:71], v5 offset:7168
  ds_read_b32 v74, v6 offset:17280
  v_exp_f32 v40, v40
  v_exp_f32 v41, v41
  v_exp_f32 v42, v42
  v_exp_f32 v43, v43
  s_waitcnt lgkmcnt(3)
  v_smfmac_f32_32x32x32_bf16 v[48:63], v[76:79], v[32:39], v14
  v_exp_f32 v44, v44
  v_exp_f32 v45, v45
  v_exp_f32 v46, v46
  v_exp_f32 v47, v47
  ds_read_b128 v[76:79], v7 offset:25728
  s_add_u32 s74, s74, 2048
  buffer_load_dwordx4 v[96:99], v144, s[8:11], s74 offen sc1
  s_setprio 0
  s_waitcnt lgkmcnt(3)
  v_smfmac_f32_32x32x32_bf16 v[48:63], v[80:83], v[40:47], v14
  ds_read_b128 v[80:83], v7 offset:26336
  v_exp_f32 v16, v16
  v_exp_f32 v17, v17
  v_exp_f32 v18, v18
  v_exp_f32 v19, v19
  s_waitcnt lgkmcnt(2)
  v_mfma_f32_32x32x16_bf16 v[32:47], v[68:71], v[8:11], 0
  v_exp_f32 v20, v20
  v_exp_f32 v21, v21
  v_exp_f32 v22, v22
  v_exp_f32 v23, v23
  v_mfma_f32_32x32x8_bf16 v[32:47], v[74:75], v[12:13], v[32:47]
  ds_read_b128 v[64:67], v5 offset:8192
  ds_read_b32 v72, v6 offset:17408
  v_exp_f32 v24, v24
  v_exp_f32 v25, v25
  v_exp_f32 v26, v26
  v_exp_f32 v27, v27
  s_waitcnt lgkmcnt(3)
  v_smfmac_f32_32x32x32_bf16 v[48:63], v[76:79], v[16:23], v14
  v_exp_f32 v28, v28
  v_exp_f32 v29, v29
  v_exp_f32 v30, v30
  v_exp_f32 v31, v31
  ds_read_b128 v[76:79], v7 offset:26944
  s_setprio 1
  s_waitcnt lgkmcnt(3)
  v_smfmac_f32_32x32x32_bf16 v[48:63], v[80:83], v[24:31], v14
  ds_read_b128 v[80:83], v7 offset:27552
  v_exp_f32 v32, v32
  v_exp_f32 v33, v33
  v_exp_f32 v34, v34
  v_exp_f32 v35, v35
  s_waitcnt lgkmcnt(2)
  v_mfma_f32_32x32x16_bf16 v[16:31], v[64:67], v[8:11], 0
  v_exp_f32 v36, v36
  v_exp_f32 v37, v37
  v_exp_f32 v38, v38
  v_exp_f32 v39, v39
  v_mfma_f32_32x32x8_bf16 v[16:31], v[72:73], v[12:13], v[16:31]
  ds_read_b128 v[68:71], v5 offset:9216
  ds_read_b32 v74, v6 offset:17536
  v_exp_f32 v40, v40
  v_exp_f32 v41, v41
  v_exp_f32 v42, v42
  v_exp_f32 v43, v43
  s_waitcnt lgkmcnt(3)
  v_smfmac_f32_32x32x32_bf16 v[48:63], v[76:79], v[32:39], v14
  v_exp_f32 v44, v44
  v_exp_f32 v45, v45
  v_exp_f32 v46, v46
  v_exp_f32 v47, v47
  ds_read_b128 v[76:79], v7 offset:28160
  s_setprio 0
  s_waitcnt lgkmcnt(3)
  v_smfmac_f32_32x32x32_bf16 v[48:63], v[80:83], v[40:47], v14
  ds_read_b128 v[80:83], v7 offset:28768
  v_exp_f32 v16, v16
  v_exp_f32 v17, v17
  v_exp_f32 v18, v18
  v_exp_f32 v19, v19
  s_waitcnt lgkmcnt(2)
  v_mfma_f32_32x32x16_bf16 v[32:47], v[68:71], v[8:11], 0
  v_exp_f32 v20, v20
  v_exp_f32 v21, v21
  v_exp_f32 v22, v22
  v_exp_f32 v23, v23
  v_mfma_f32_32x32x8_bf16 v[32:47], v[74:75], v[12:13], v[32:47]
  ds_read_b128 v[64:67], v5 offset:10240
  ds_read_b32 v72, v6 offset:17664
  v_exp_f32 v24, v24
  v_exp_f32 v25, v25
  v_exp_f32 v26, v26
  v_exp_f32 v27, v27
  s_waitcnt lgkmcnt(3)
  v_smfmac_f32_32x32x32_bf16 v[48:63], v[76:79], v[16:23], v14
  v_exp_f32 v28, v28
  v_exp_f32 v29, v29
  v_exp_f32 v30, v30
  v_exp_f32 v31, v31
  ds_read_b128 v[76:79], v7 offset:29376
  s_setprio 1
  s_waitcnt lgkmcnt(3)
  v_smfmac_f32_32x32x32_bf16 v[48:63], v[80:83], v[24:31], v14
  ds_read_b128 v[80:83], v7 offset:29984
  v_exp_f32 v32, v32
  v_exp_f32 v33, v33
  v_exp_f32 v34, v34
  v_exp_f32 v35, v35
  s_waitcnt lgkmcnt(2)
  v_mfma_f32_32x32x16_bf16 v[16:31], v[64:67], v[8:11], 0
  v_exp_f32 v36, v36
  v_exp_f32 v37, v37
  v_exp_f32 v38, v38
  v_exp_f32 v39, v39
  v_mfma_f32_32x32x8_bf16 v[16:31], v[72:73], v[12:13], v[16:31]
  ds_read_b128 v[68:71], v5 offset:11264
  ds_read_b32 v74, v6 offset:17792
  v_exp_f32 v40, v40
  v_exp_f32 v41, v41
  v_exp_f32 v42, v42
  v_exp_f32 v43, v43
  s_waitcnt lgkmcnt(3)
  v_smfmac_f32_32x32x32_bf16 v[48:63], v[76:79], v[32:39], v14
  v_exp_f32 v44, v44
  v_exp_f32 v45, v45
  v_exp_f32 v46, v46
  v_exp_f32 v47, v47
  ds_read_b128 v[76:79], v7 offset:30592
  s_waitcnt vmcnt(0)
  v_add_f32 v84, v84, v88
  v_add_f32 v92, v92, v96
  v_add_f32 v85, v85, v89
  v_add_f32 v93, v93, v97
  v_add_f32 v86, v86, v90
  v_add_f32 v94, v94, v98
  v_add_f32 v87, v87, v91
  v_add_f32 v95, v95, v99
  v_add_f32 v84, v84, v92
  v_add_f32 v85, v85, v93
  v_add_f32 v86, v86, v94
  v_add_f32 v87, v87, v95
  v_mov_b32 v88, v84
  v_mov_b32 v89, v85
  v_mov_b32 v90, v86
  v_mov_b32 v91, v87
  s_setprio 0
  s_waitcnt lgkmcnt(3)
  v_smfmac_f32_32x32x32_bf16 v[48:63], v[80:83], v[40:47], v14
  ds_read_b128 v[80:83], v7 offset:31200
  v_exp_f32 v16, v16
  v_exp_f32 v17, v17
  v_exp_f32 v18, v18
  v_exp_f32 v19, v19
  s_waitcnt lgkmcnt(2)
  v_mfma_f32_32x32x16_bf16 v[32:47], v[68:71], v[8:11], 0
  v_exp_f32 v20, v20
  v_exp_f32 v21, v21
  v_exp_f32 v22, v22
  v_exp_f32 v23, v23
  v_mfma_f32_32x32x8_bf16 v[32:47], v[74:75], v[12:13], v[32:47]
  ds_read_b128 v[64:67], v5 offset:12288
  ds_read_b32 v72, v6 offset:17920
  v_exp_f32 v24, v24
  v_exp_f32 v25, v25
  v_exp_f32 v26, v26
  v_exp_f32 v27, v27
  s_waitcnt lgkmcnt(3)
  v_smfmac_f32_32x32x32_bf16 v[48:63], v[76:79], v[16:23], v14
  v_exp_f32 v28, v28
  v_exp_f32 v29, v29
  v_exp_f32 v30, v30
  v_exp_f32 v31, v31
  ds_read_b128 v[76:79], v7 offset:31808
  v_permlane32_swap_b32 v84, v88
  v_permlane32_swap_b32 v85, v89
  v_permlane32_swap_b32 v86, v90
  v_permlane32_swap_b32 v87, v91
  s_nop 1
  v_add_f32 v84, v84, v88
  v_add_f32 v85, v85, v89
  v_add_f32 v86, v86, v90
  v_add_f32 v87, v87, v91
  v_mov_b32 v88, v84
  v_mov_b32 v89, v85
  v_mov_b32 v90, v86
  v_mov_b32 v91, v87
  s_setprio 1
  s_waitcnt lgkmcnt(3)
  v_smfmac_f32_32x32x32_bf16 v[48:63], v[80:83], v[24:31], v14
  ds_read_b128 v[80:83], v7 offset:32416
  v_exp_f32 v32, v32
  v_exp_f32 v33, v33
  v_exp_f32 v34, v34
  v_exp_f32 v35, v35
  s_waitcnt lgkmcnt(2)
  v_mfma_f32_32x32x16_bf16 v[16:31], v[64:67], v[8:11], 0
  v_exp_f32 v36, v36
  v_exp_f32 v37, v37
  v_exp_f32 v38, v38
  v_exp_f32 v39, v39
  v_mfma_f32_32x32x8_bf16 v[16:31], v[72:73], v[12:13], v[16:31]
  ds_read_b128 v[68:71], v5 offset:13312
  ds_read_b32 v74, v6 offset:18048
  v_exp_f32 v40, v40
  v_exp_f32 v41, v41
  v_exp_f32 v42, v42
  v_exp_f32 v43, v43
  s_waitcnt lgkmcnt(3)
  v_smfmac_f32_32x32x32_bf16 v[48:63], v[76:79], v[32:39], v14
  v_exp_f32 v44, v44
  v_exp_f32 v45, v45
  v_exp_f32 v46, v46
  v_exp_f32 v47, v47
  ds_read_b128 v[76:79], v7 offset:33024
  v_permlane16_swap_b32 v84, v88
  v_permlane16_swap_b32 v85, v89
  v_permlane16_swap_b32 v86, v90
  v_permlane16_swap_b32 v87, v91
  s_nop 1
  v_add_f32 v84, v84, v88
  v_add_f32 v85, v85, v89
  v_add_f32 v86, v86, v90
  v_add_f32 v87, v87, v91
  s_setprio 0
  s_waitcnt lgkmcnt(3)
  v_smfmac_f32_32x32x32_bf16 v[48:63], v[80:83], v[40:47], v14
  ds_read_b128 v[80:83], v7 offset:33632
  v_exp_f32 v16, v16
  v_exp_f32 v17, v17
  v_exp_f32 v18, v18
  v_exp_f32 v19, v19
  s_waitcnt lgkmcnt(2)
  v_mfma_f32_32x32x16_bf16 v[32:47], v[68:71], v[8:11], 0
  v_exp_f32 v20, v20
  v_exp_f32 v21, v21
  v_exp_f32 v22, v22
  v_exp_f32 v23, v23
  v_mfma_f32_32x32x8_bf16 v[32:47], v[74:75], v[12:13], v[32:47]
  ds_read_b128 v[64:67], v5 offset:14336
  ds_read_b32 v72, v6 offset:18176
  v_exp_f32 v24, v24
  v_exp_f32 v25, v25
  v_exp_f32 v26, v26
  v_exp_f32 v27, v27
  s_waitcnt lgkmcnt(3)
  v_smfmac_f32_32x32x32_bf16 v[48:63], v[76:79], v[16:23], v14
  v_exp_f32 v28, v28
  v_exp_f32 v29, v29
  v_exp_f32 v30, v30
  v_exp_f32 v31, v31
  ds_read_b128 v[76:79], v7 offset:34240
  v_cvt_pk_bf16_f32 v84, v84, v85
  v_cvt_pk_bf16_f32 v85, v86, v87
  ds_write_b64 v145, v[84:85]
  s_setprio 1
  s_waitcnt lgkmcnt(3)
  v_smfmac_f32_32x32x32_bf16 v[48:63], v[80:83], v[24:31], v14
  ds_read_b128 v[80:83], v7 offset:34848
  v_exp_f32 v32, v32
  v_exp_f32 v33, v33
  v_exp_f32 v34, v34
  v_exp_f32 v35, v35
  s_waitcnt lgkmcnt(2)
  v_mfma_f32_32x32x16_bf16 v[16:31], v[64:67], v[8:11], 0
  v_exp_f32 v36, v36
  v_exp_f32 v37, v37
  v_exp_f32 v38, v38
  v_exp_f32 v39, v39
  v_mfma_f32_32x32x8_bf16 v[16:31], v[72:73], v[12:13], v[16:31]
  ds_read_b128 v[68:71], v5 offset:15360
  ds_read_b32 v74, v6 offset:18304
  v_exp_f32 v40, v40
  v_exp_f32 v41, v41
  v_exp_f32 v42, v42
  v_exp_f32 v43, v43
  s_waitcnt lgkmcnt(3)
  v_smfmac_f32_32x32x32_bf16 v[48:63], v[76:79], v[32:39], v14
  v_exp_f32 v44, v44
  v_exp_f32 v45, v45
  v_exp_f32 v46, v46
  v_exp_f32 v47, v47
  ds_read_b128 v[76:79], v7 offset:35456
  s_waitcnt vmcnt(0)
  s_barrier
  s_setprio 0
  s_waitcnt lgkmcnt(3)
  v_smfmac_f32_32x32x32_bf16 v[48:63], v[80:83], v[40:47], v14
  ds_read_b128 v[80:83], v7 offset:36064
  v_exp_f32 v16, v16
  v_exp_f32 v17, v17
  v_exp_f32 v18, v18
  v_exp_f32 v19, v19
  s_waitcnt lgkmcnt(2)
  v_mfma_f32_32x32x16_bf16 v[32:47], v[68:71], v[8:11], 0
  v_exp_f32 v20, v20
  v_exp_f32 v21, v21
  v_exp_f32 v22, v22
  v_exp_f32 v23, v23
  v_mfma_f32_32x32x8_bf16 v[32:47], v[74:75], v[12:13], v[32:47]
  ds_read_b128 v[64:67], v5 offset:37888
  ds_read_b32 v72, v6 offset:54272
  v_exp_f32 v24, v24
  v_exp_f32 v25, v25
  v_exp_f32 v26, v26
  v_exp_f32 v27, v27
  s_waitcnt lgkmcnt(3)
  v_smfmac_f32_32x32x32_bf16 v[48:63], v[76:79], v[16:23], v14
  v_exp_f32 v28, v28
  v_exp_f32 v29, v29
  v_exp_f32 v30, v30
  v_exp_f32 v31, v31
  ds_read_b128 v[76:79], v7 offset:36672
  s_setprio 1
  s_waitcnt lgkmcnt(3)
  v_smfmac_f32_32x32x32_bf16 v[48:63], v[80:83], v[24:31], v14
  ds_read_b128 v[80:83], v7 offset:37280
  v_exp_f32 v32, v32
  v_exp_f32 v33, v33
  v_exp_f32 v34, v34
  v_exp_f32 v35, v35
  s_waitcnt lgkmcnt(2)
  v_mfma_f32_32x32x16_bf16 v[16:31], v[64:67], v[8:11], 0
  v_exp_f32 v36, v36
  v_exp_f32 v37, v37
  v_exp_f32 v38, v38
  v_exp_f32 v39, v39
  v_mfma_f32_32x32x8_bf16 v[16:31], v[72:73], v[12:13], v[16:31]
  ds_read_b128 v[68:71], v5 offset:38912
  ds_read_b32 v74, v6 offset:54400
  v_exp_f32 v40, v40
  v_exp_f32 v41, v41
  v_exp_f32 v42, v42
  v_exp_f32 v43, v43
  s_waitcnt lgkmcnt(3)
  v_smfmac_f32_32x32x32_bf16 v[48:63], v[76:79], v[32:39], v14
  v_exp_f32 v44, v44
  v_exp_f32 v45, v45
  v_exp_f32 v46, v46
  v_exp_f32 v47, v47
  ds_read_b128 v[76:79], v7 offset:56320
  v_add_u32 v5, 37888, v5
  v_add_u32 v6, 37888, v6
  v_add_u32 v7, 37888, v7
  s_and_b32 s28, s32, 1
  s_lshl_b32 s28, s28, 2
  s_add_u32 s28, s28, 151584
  s_mov_b32 s29, 151552
  v_mul_u32_u24 v106, 48, v15
  v_and_b32 v107, 16, v4
  v_add3_u32 v107, v106, v107, s29
  v_add_u32 v106, s28, v106
  ds_read_b128 v[84:87], v107
  ds_read_b32 v88, v106
  v_mov_b32 v89, 0
  v_mov_b32 v125, 0
  v_not_b32 v110, v4
  v_and_b32 v124, v124, v110
  s_setprio 0
  s_waitcnt lgkmcnt(3)
  v_smfmac_f32_32x32x32_bf16 v[48:63], v[80:83], v[40:47], v14
  ds_read_b128 v[80:83], v7 offset:19040
  v_exp_f32 v16, v16
  v_exp_f32 v17, v17
  v_exp_f32 v18, v18
  v_exp_f32 v19, v19
  s_waitcnt lgkmcnt(2)
  v_mfma_f32_32x32x16_bf16 v[32:47], v[68:71], v[8:11], 0
  v_exp_f32 v20, v20
  v_exp_f32 v21, v21
  v_exp_f32 v22, v22
  v_exp_f32 v23, v23
  v_mfma_f32_32x32x8_bf16 v[32:47], v[74:75], v[12:13], v[32:47]
  ds_read_b128 v[64:67], v5 offset:2048
  ds_read_b32 v72, v6 offset:16640
  v_exp_f32 v24, v24
  v_exp_f32 v25, v25
  v_exp_f32 v26, v26
  v_exp_f32 v27, v27
  s_waitcnt lgkmcnt(3)
  v_smfmac_f32_32x32x32_bf16 v[48:63], v[76:79], v[16:23], v14
  v_exp_f32 v28, v28
  v_exp_f32 v29, v29
  v_exp_f32 v30, v30
  v_exp_f32 v31, v31
  ds_read_b128 v[76:79], v7 offset:19648
  v_mfma_f32_32x32x16_bf16 v[128:143], v[84:87], v[120:123], 0
  v_mfma_f32_32x32x8_bf16 v[128:143], v[88:89], v[124:125], v[128:143]
  s_setprio 1
  s_waitcnt lgkmcnt(3)
  v_smfmac_f32_32x32x32_bf16 v[48:63], v[80:83], v[24:31], v14
  ds_read_b128 v[80:83], v7 offset:20256
  v_exp_f32 v32, v32
  v_exp_f32 v33, v33
  v_exp_f32 v34, v34
  v_exp_f32 v35, v35
  s_waitcnt lgkmcnt(2)
  v_mfma_f32_32x32x16_bf16 v[16:31], v[64:67], v[8:11], 0
  v_exp_f32 v36, v36
  v_exp_f32 v37, v37
  v_exp_f32 v38, v38
  v_exp_f32 v39, v39
  v_mfma_f32_32x32x8_bf16 v[16:31], v[72:73], v[12:13], v[16:31]
  ds_read_b128 v[68:71], v5 offset:3072
  ds_read_b32 v74, v6 offset:16768
  v_exp_f32 v40, v40
  v_exp_f32 v41, v41
  v_exp_f32 v42, v42
  v_exp_f32 v43, v43
  s_waitcnt lgkmcnt(3)
  v_smfmac_f32_32x32x32_bf16 v[48:63], v[76:79], v[32:39], v14
  v_exp_f32 v44, v44
  v_exp_f32 v45, v45
  v_exp_f32 v46, v46
  v_exp_f32 v47, v47
  ds_read_b128 v[76:79], v7 offset:20864
  v_add_f32 v138, 0x358637bd, v138
  v_rcp_f32 v100, v138
  s_nop 0
  v_mul_f32 v128, v128, v100
  v_mul_f32 v129, v129, v100
  v_mul_f32 v130, v130, v100
  v_mul_f32 v131, v131, v100
  v_mul_f32 v132, v132, v100
  v_mul_f32 v133, v133, v100
  v_mul_f32 v134, v134, v100
  v_mul_f32 v135, v135, v100
  v_mul_f32 v136, v136, v100
  v_mul_f32 v137, v137, v100
  v_cvt_pk_bf16_f32 v104, v128, v129
  v_cvt_pk_bf16_f32 v105, v130, v131
  v_cvt_pk_bf16_f32 v106, v132, v133
  v_cvt_pk_bf16_f32 v107, v134, v135
  v_cvt_pk_bf16_f32 v108, v136, v137
  s_add_u32 s28, s35, 14680064
  s_add_u32 s29, s36, 16777216
  buffer_store_dwordx4 v[104:107], v102, s[8:11], s28 offen sc1
  buffer_store_dword v108, v103, s[8:11], s29 offen sc1
  s_setprio 0
  s_waitcnt lgkmcnt(3)
  v_smfmac_f32_32x32x32_bf16 v[48:63], v[80:83], v[40:47], v14
  ds_read_b128 v[80:83], v7 offset:21472
  v_exp_f32 v16, v16
  v_exp_f32 v17, v17
  v_exp_f32 v18, v18
  v_exp_f32 v19, v19
  s_waitcnt lgkmcnt(2)
  v_mfma_f32_32x32x16_bf16 v[32:47], v[68:71], v[8:11], 0
  v_exp_f32 v20, v20
  v_exp_f32 v21, v21
  v_exp_f32 v22, v22
  v_exp_f32 v23, v23
  v_mfma_f32_32x32x8_bf16 v[32:47], v[74:75], v[12:13], v[32:47]
  ds_read_b128 v[64:67], v5 offset:4096
  ds_read_b32 v72, v6 offset:16896
  v_exp_f32 v24, v24
  v_exp_f32 v25, v25
  v_exp_f32 v26, v26
  v_exp_f32 v27, v27
  s_waitcnt lgkmcnt(3)
  v_smfmac_f32_32x32x32_bf16 v[48:63], v[76:79], v[16:23], v14
  v_exp_f32 v28, v28
  v_exp_f32 v29, v29
  v_exp_f32 v30, v30
  v_exp_f32 v31, v31
  ds_read_b128 v[76:79], v7 offset:22080
  s_setprio 1
  s_waitcnt lgkmcnt(3)
  v_smfmac_f32_32x32x32_bf16 v[48:63], v[80:83], v[24:31], v14
  ds_read_b128 v[80:83], v7 offset:22688
  v_exp_f32 v32, v32
  v_exp_f32 v33, v33
  v_exp_f32 v34, v34
  v_exp_f32 v35, v35
  s_waitcnt lgkmcnt(2)
  v_mfma_f32_32x32x16_bf16 v[16:31], v[64:67], v[8:11], 0
  v_exp_f32 v36, v36
  v_exp_f32 v37, v37
  v_exp_f32 v38, v38
  v_exp_f32 v39, v39
  v_mfma_f32_32x32x8_bf16 v[16:31], v[72:73], v[12:13], v[16:31]
  ds_read_b128 v[68:71], v5 offset:5120
  ds_read_b32 v74, v6 offset:17024
  v_exp_f32 v40, v40
  v_exp_f32 v41, v41
  v_exp_f32 v42, v42
  v_exp_f32 v43, v43
  s_waitcnt lgkmcnt(3)
  v_smfmac_f32_32x32x32_bf16 v[48:63], v[76:79], v[32:39], v14
  v_exp_f32 v44, v44
  v_exp_f32 v45, v45
  v_exp_f32 v46, v46
  v_exp_f32 v47, v47
  ds_read_b128 v[76:79], v7 offset:23296
  s_setprio 0
  s_waitcnt lgkmcnt(3)
  v_smfmac_f32_32x32x32_bf16 v[48:63], v[80:83], v[40:47], v14
  ds_read_b128 v[80:83], v7 offset:23904
  v_exp_f32 v16, v16
  v_exp_f32 v17, v17
  v_exp_f32 v18, v18
  v_exp_f32 v19, v19
  s_waitcnt lgkmcnt(2)
  v_mfma_f32_32x32x16_bf16 v[32:47], v[68:71], v[8:11], 0
  v_exp_f32 v20, v20
  v_exp_f32 v21, v21
  v_exp_f32 v22, v22
  v_exp_f32 v23, v23
  v_mfma_f32_32x32x8_bf16 v[32:47], v[74:75], v[12:13], v[32:47]
  ds_read_b128 v[64:67], v5 offset:6144
  ds_read_b32 v72, v6 offset:17152
  v_exp_f32 v24, v24
  v_exp_f32 v25, v25
  v_exp_f32 v26, v26
  v_exp_f32 v27, v27
  s_waitcnt lgkmcnt(3)
  v_smfmac_f32_32x32x32_bf16 v[48:63], v[76:79], v[16:23], v14
  v_exp_f32 v28, v28
  v_exp_f32 v29, v29
  v_exp_f32 v30, v30
  v_exp_f32 v31, v31
  ds_read_b128 v[76:79], v7 offset:24512
  s_setprio 1
  s_waitcnt lgkmcnt(3)
  v_smfmac_f32_32x32x32_bf16 v[48:63], v[80:83], v[24:31], v14
  ds_read_b128 v[80:83], v7 offset:25120
  v_exp_f32 v32, v32
  v_exp_f32 v33, v33
  v_exp_f32 v34, v34
  v_exp_f32 v35, v35
  s_waitcnt lgkmcnt(2)
  v_mfma_f32_32x32x16_bf16 v[16:31], v[64:67], v[8:11], 0
  v_exp_f32 v36, v36
  v_exp_f32 v37, v37
  v_exp_f32 v38, v38
  v_exp_f32 v39, v39
  v_mfma_f32_32x32x8_bf16 v[16:31], v[72:73], v[12:13], v[16:31]
  ds_read_b128 v[68:71], v5 offset:7168
  ds_read_b32 v74, v6 offset:17280
  v_exp_f32 v40, v40
  v_exp_f32 v41, v41
  v_exp_f32 v42, v42
  v_exp_f32 v43, v43
  s_waitcnt lgkmcnt(3)
  v_smfmac_f32_32x32x32_bf16 v[48:63], v[76:79], v[32:39], v14
  v_exp_f32 v44, v44
  v_exp_f32 v45, v45
  v_exp_f32 v46, v46
  v_exp_f32 v47, v47
  ds_read_b128 v[76:79], v7 offset:25728
  s_setprio 0
  s_waitcnt lgkmcnt(3)
  v_smfmac_f32_32x32x32_bf16 v[48:63], v[80:83], v[40:47], v14
  ds_read_b128 v[80:83], v7 offset:26336
  v_exp_f32 v16, v16
  v_exp_f32 v17, v17
  v_exp_f32 v18, v18
  v_exp_f32 v19, v19
  s_waitcnt lgkmcnt(2)
  v_mfma_f32_32x32x16_bf16 v[32:47], v[68:71], v[8:11], 0
  v_exp_f32 v20, v20
  v_exp_f32 v21, v21
  v_exp_f32 v22, v22
  v_exp_f32 v23, v23
  v_mfma_f32_32x32x8_bf16 v[32:47], v[74:75], v[12:13], v[32:47]
  ds_read_b128 v[64:67], v5 offset:8192
  ds_read_b32 v72, v6 offset:17408
  v_exp_f32 v24, v24
  v_exp_f32 v25, v25
  v_exp_f32 v26, v26
  v_exp_f32 v27, v27
  s_waitcnt lgkmcnt(3)
  v_smfmac_f32_32x32x32_bf16 v[48:63], v[76:79], v[16:23], v14
  v_exp_f32 v28, v28
  v_exp_f32 v29, v29
  v_exp_f32 v30, v30
  v_exp_f32 v31, v31
  ds_read_b128 v[76:79], v7 offset:26944
  s_setprio 1
  s_waitcnt lgkmcnt(3)
  v_smfmac_f32_32x32x32_bf16 v[48:63], v[80:83], v[24:31], v14
  ds_read_b128 v[80:83], v7 offset:27552
  v_exp_f32 v32, v32
  v_exp_f32 v33, v33
  v_exp_f32 v34, v34
  v_exp_f32 v35, v35
  s_waitcnt lgkmcnt(2)
  v_mfma_f32_32x32x16_bf16 v[16:31], v[64:67], v[8:11], 0
  v_exp_f32 v36, v36
  v_exp_f32 v37, v37
  v_exp_f32 v38, v38
  v_exp_f32 v39, v39
  v_mfma_f32_32x32x8_bf16 v[16:31], v[72:73], v[12:13], v[16:31]
  ds_read_b128 v[68:71], v5 offset:9216
  ds_read_b32 v74, v6 offset:17536
  v_exp_f32 v40, v40
  v_exp_f32 v41, v41
  v_exp_f32 v42, v42
  v_exp_f32 v43, v43
  s_waitcnt lgkmcnt(3)
  v_smfmac_f32_32x32x32_bf16 v[48:63], v[76:79], v[32:39], v14
  v_exp_f32 v44, v44
  v_exp_f32 v45, v45
  v_exp_f32 v46, v46
  v_exp_f32 v47, v47
  ds_read_b128 v[76:79], v7 offset:28160
  s_setprio 0
  s_waitcnt lgkmcnt(3)
  v_smfmac_f32_32x32x32_bf16 v[48:63], v[80:83], v[40:47], v14
  ds_read_b128 v[80:83], v7 offset:28768
  v_exp_f32 v16, v16
  v_exp_f32 v17, v17
  v_exp_f32 v18, v18
  v_exp_f32 v19, v19
  s_waitcnt lgkmcnt(2)
  v_mfma_f32_32x32x16_bf16 v[32:47], v[68:71], v[8:11], 0
  v_exp_f32 v20, v20
  v_exp_f32 v21, v21
  v_exp_f32 v22, v22
  v_exp_f32 v23, v23
  v_mfma_f32_32x32x8_bf16 v[32:47], v[74:75], v[12:13], v[32:47]
  ds_read_b128 v[64:67], v5 offset:10240
  ds_read_b32 v72, v6 offset:17664
  v_exp_f32 v24, v24
  v_exp_f32 v25, v25
  v_exp_f32 v26, v26
  v_exp_f32 v27, v27
  s_waitcnt lgkmcnt(3)
  v_smfmac_f32_32x32x32_bf16 v[48:63], v[76:79], v[16:23], v14
  v_exp_f32 v28, v28
  v_exp_f32 v29, v29
  v_exp_f32 v30, v30
  v_exp_f32 v31, v31
  ds_read_b128 v[76:79], v7 offset:29376
  s_setprio 1
  s_waitcnt lgkmcnt(3)
  v_smfmac_f32_32x32x32_bf16 v[48:63], v[80:83], v[24:31], v14
  ds_read_b128 v[80:83], v7 offset:29984
  v_exp_f32 v32, v32
  v_exp_f32 v33, v33
  v_exp_f32 v34, v34
  v_exp_f32 v35, v35
  s_waitcnt lgkmcnt(2)
  v_mfma_f32_32x32x16_bf16 v[16:31], v[64:67], v[8:11], 0
  v_exp_f32 v36, v36
  v_exp_f32 v37, v37
  v_exp_f32 v38, v38
  v_exp_f32 v39, v39
  v_mfma_f32_32x32x8_bf16 v[16:31], v[72:73], v[12:13], v[16:31]
  ds_read_b128 v[68:71], v5 offset:11264
  ds_read_b32 v74, v6 offset:17792
  v_exp_f32 v40, v40
  v_exp_f32 v41, v41
  v_exp_f32 v42, v42
  v_exp_f32 v43, v43
  s_waitcnt lgkmcnt(3)
  v_smfmac_f32_32x32x32_bf16 v[48:63], v[76:79], v[32:39], v14
  v_exp_f32 v44, v44
  v_exp_f32 v45, v45
  v_exp_f32 v46, v46
  v_exp_f32 v47, v47
  ds_read_b128 v[76:79], v7 offset:30592
  s_setprio 0
  s_waitcnt lgkmcnt(3)
  v_smfmac_f32_32x32x32_bf16 v[48:63], v[80:83], v[40:47], v14
  ds_read_b128 v[80:83], v7 offset:31200
  v_exp_f32 v16, v16
  v_exp_f32 v17, v17
  v_exp_f32 v18, v18
  v_exp_f32 v19, v19
  s_waitcnt lgkmcnt(2)
  v_mfma_f32_32x32x16_bf16 v[32:47], v[68:71], v[8:11], 0
  v_exp_f32 v20, v20
  v_exp_f32 v21, v21
  v_exp_f32 v22, v22
  v_exp_f32 v23, v23
  v_mfma_f32_32x32x8_bf16 v[32:47], v[74:75], v[12:13], v[32:47]
  ds_read_b128 v[64:67], v5 offset:12288
  ds_read_b32 v72, v6 offset:17920
  v_exp_f32 v24, v24
  v_exp_f32 v25, v25
  v_exp_f32 v26, v26
  v_exp_f32 v27, v27
  s_waitcnt lgkmcnt(3)
  v_smfmac_f32_32x32x32_bf16 v[48:63], v[76:79], v[16:23], v14
  v_exp_f32 v28, v28
  v_exp_f32 v29, v29
  v_exp_f32 v30, v30
  v_exp_f32 v31, v31
  ds_read_b128 v[76:79], v7 offset:31808
  s_setprio 1
  s_waitcnt lgkmcnt(3)
  v_smfmac_f32_32x32x32_bf16 v[48:63], v[80:83], v[24:31], v14
  ds_read_b128 v[80:83], v7 offset:32416
  v_exp_f32 v32, v32
  v_exp_f32 v33, v33
  v_exp_f32 v34, v34
  v_exp_f32 v35, v35
  s_waitcnt lgkmcnt(2)
  v_mfma_f32_32x32x16_bf16 v[16:31], v[64:67], v[8:11], 0
  v_exp_f32 v36, v36
  v_exp_f32 v37, v37
  v_exp_f32 v38, v38
  v_exp_f32 v39, v39
  v_mfma_f32_32x32x8_bf16 v[16:31], v[72:73], v[12:13], v[16:31]
  ds_read_b128 v[68:71], v5 offset:13312
  ds_read_b32 v74, v6 offset:18048
  v_exp_f32 v40, v40
  v_exp_f32 v41, v41
  v_exp_f32 v42, v42
  v_exp_f32 v43, v43
  s_waitcnt lgkmcnt(3)
  v_smfmac_f32_32x32x32_bf16 v[48:63], v[76:79], v[32:39], v14
  v_exp_f32 v44, v44
  v_exp_f32 v45, v45
  v_exp_f32 v46, v46
  v_exp_f32 v47, v47
  ds_read_b128 v[76:79], v7 offset:33024
  s_setprio 0
  s_waitcnt lgkmcnt(3)
  v_smfmac_f32_32x32x32_bf16 v[48:63], v[80:83], v[40:47], v14
  ds_read_b128 v[80:83], v7 offset:33632
  v_exp_f32 v16, v16
  v_exp_f32 v17, v17
  v_exp_f32 v18, v18
  v_exp_f32 v19, v19
  s_waitcnt lgkmcnt(2)
  v_mfma_f32_32x32x16_bf16 v[32:47], v[68:71], v[8:11], 0
  v_exp_f32 v20, v20
  v_exp_f32 v21, v21
  v_exp_f32 v22, v22
  v_exp_f32 v23, v23
  v_mfma_f32_32x32x8_bf16 v[32:47], v[74:75], v[12:13], v[32:47]
  ds_read_b128 v[64:67], v5 offset:14336
  ds_read_b32 v72, v6 offset:18176
  v_exp_f32 v24, v24
  v_exp_f32 v25, v25
  v_exp_f32 v26, v26
  v_exp_f32 v27, v27
  s_waitcnt lgkmcnt(3)
  v_smfmac_f32_32x32x32_bf16 v[48:63], v[76:79], v[16:23], v14
  v_exp_f32 v28, v28
  v_exp_f32 v29, v29
  v_exp_f32 v30, v30
  v_exp_f32 v31, v31
  ds_read_b128 v[76:79], v7 offset:34240
  s_setprio 1
  s_waitcnt lgkmcnt(3)
  v_smfmac_f32_32x32x32_bf16 v[48:63], v[80:83], v[24:31], v14
  ds_read_b128 v[80:83], v7 offset:34848
  v_exp_f32 v32, v32
  v_exp_f32 v33, v33
  v_exp_f32 v34, v34
  v_exp_f32 v35, v35
  s_waitcnt lgkmcnt(2)
  v_mfma_f32_32x32x16_bf16 v[16:31], v[64:67], v[8:11], 0
  v_exp_f32 v36, v36
  v_exp_f32 v37, v37
  v_exp_f32 v38, v38
  v_exp_f32 v39, v39
  v_mfma_f32_32x32x8_bf16 v[16:31], v[72:73], v[12:13], v[16:31]
  ds_read_b128 v[68:71], v5 offset:15360
  ds_read_b32 v74, v6 offset:18304
  v_exp_f32 v40, v40
  v_exp_f32 v41, v41
  v_exp_f32 v42, v42
  v_exp_f32 v43, v43
  s_waitcnt lgkmcnt(3)
  v_smfmac_f32_32x32x32_bf16 v[48:63], v[76:79], v[32:39], v14
  v_exp_f32 v44, v44
  v_exp_f32 v45, v45
  v_exp_f32 v46, v46
  v_exp_f32 v47, v47
  ds_read_b128 v[76:79], v7 offset:35456
  s_setprio 0
  s_waitcnt lgkmcnt(3)
  v_smfmac_f32_32x32x32_bf16 v[48:63], v[80:83], v[40:47], v14
  ds_read_b128 v[80:83], v7 offset:36064
  v_exp_f32 v16, v16
  v_exp_f32 v17, v17
  v_exp_f32 v18, v18
  v_exp_f32 v19, v19
  s_waitcnt lgkmcnt(2)
  v_mfma_f32_32x32x16_bf16 v[32:47], v[68:71], v[8:11], 0
  v_exp_f32 v20, v20
  v_exp_f32 v21, v21
  v_exp_f32 v22, v22
  v_exp_f32 v23, v23
  v_mfma_f32_32x32x8_bf16 v[32:47], v[74:75], v[12:13], v[32:47]
  ds_read_b128 v[64:67], v5 offset:37888
  ds_read_b32 v72, v6 offset:54272
  v_exp_f32 v24, v24
  v_exp_f32 v25, v25
  v_exp_f32 v26, v26
  v_exp_f32 v27, v27
  s_waitcnt lgkmcnt(3)
  v_smfmac_f32_32x32x32_bf16 v[48:63], v[76:79], v[16:23], v14
  v_exp_f32 v28, v28
  v_exp_f32 v29, v29
  v_exp_f32 v30, v30
  v_exp_f32 v31, v31
  ds_read_b128 v[76:79], v7 offset:36672
  s_setprio 1
  s_waitcnt lgkmcnt(3)
  v_smfmac_f32_32x32x32_bf16 v[48:63], v[80:83], v[24:31], v14
  ds_read_b128 v[80:83], v7 offset:37280
  v_exp_f32 v32, v32
  v_exp_f32 v33, v33
  v_exp_f32 v34, v34
  v_exp_f32 v35, v35
  s_waitcnt lgkmcnt(2)
  v_mfma_f32_32x32x16_bf16 v[16:31], v[64:67], v[8:11], 0
  v_exp_f32 v36, v36
  v_exp_f32 v37, v37
  v_exp_f32 v38, v38
  v_exp_f32 v39, v39
  v_mfma_f32_32x32x8_bf16 v[16:31], v[72:73], v[12:13], v[16:31]
  ds_read_b128 v[68:71], v5 offset:38912
  ds_read_b32 v74, v6 offset:54400
  v_exp_f32 v40, v40
  v_exp_f32 v41, v41
  v_exp_f32 v42, v42
  v_exp_f32 v43, v43
  s_waitcnt lgkmcnt(3)
  v_smfmac_f32_32x32x32_bf16 v[48:63], v[76:79], v[32:39], v14
  v_exp_f32 v44, v44
  v_exp_f32 v45, v45
  v_exp_f32 v46, v46
  v_exp_f32 v47, v47
  ds_read_b128 v[76:79], v7 offset:56320
  v_add_u32 v5, 37888, v5
  v_add_u32 v6, 37888, v6
  v_add_u32 v7, 37888, v7
  s_waitcnt lgkmcnt(3)
  .p2align 6
P2_LOOP:
  s_branch P2_FIN
P2_REPOLL:
  s_and_b32 s28, s2, 7
  s_lshl_b32 s28, s28, 11
  s_add_u32 s28, s28, 17842176
  s_mov_b32 s31, 200000
P2_PF_L:
  buffer_load_dword v106, v127, s[8:11], s28 offen sc1
  s_waitcnt vmcnt(0)
  v_cmp_ne_u32 vcc, 1, v106
  s_nop 3
  s_cmp_eq_u64 vcc, 0
  s_cbranch_scc1 P2_PF_D
  s_sub_u32 s31, s31, 1
  s_cmp_lg_u32 s31, 0
  s_cbranch_scc1 P2_PF_L
P2_PF_D:
  s_waitcnt vmcnt(0)
  s_branch P2_I2
P2_FIN:
  s_waitcnt lgkmcnt(0)
  s_setprio 0
  v_smfmac_f32_32x32x32_bf16 v[48:63], v[80:83], v[40:47], v14
  s_nop 7
  s_nop 7
  v_add_f32_e64 v108, abs(v48), abs(v49)
  v_add_f32_e64 v108, v108, abs(v50)
  v_add_f32_e64 v108, v108, abs(v51)
  v_add_f32_e64 v108, v108, abs(v52)
  v_add_f32_e64 v108, v108, abs(v53)
  v_add_f32_e64 v108, v108, abs(v54)
  v_add_f32_e64 v108, v108, abs(v55)
  v_add_f32_e64 v108, v108, abs(v56)
  v_add_f32_e64 v108, v108, abs(v57)
  s_mov_b32 s30, 0x5d800000
  s_mov_b32 s31, 0x21800000
  v_cmp_gt_f32 vcc, 0x7f800000, v108
  v_cmp_le_f32 s[4:5], v58, s30
  v_cmp_ge_f32 s[6:7], v58, s31
  s_nop 3
  s_and_b64 vcc, vcc, s[4:5]
  s_and_b64 vcc, vcc, s[6:7]
  s_cmp_eq_u64 vcc, exec
  s_cbranch_scc0 P2_SLOW
P2_NORM:
  v_rcp_f32 v100, v58
  s_nop 0
  v_mul_f32 v48, v48, v100
  v_mul_f32 v49, v49, v100
  v_mul_f32 v50, v50, v100
  v_mul_f32 v51, v51, v100
  v_mul_f32 v52, v52, v100
  v_mul_f32 v53, v53, v100
  v_mul_f32 v54, v54, v100
  v_mul_f32 v55, v55, v100
  v_mul_f32 v56, v56, v100
  v_mul_f32 v57, v57, v100
  v_cvt_pk_bf16_f32 v104, v48, v49
  v_cvt_pk_bf16_f32 v105, v50, v51
  v_cvt_pk_bf16_f32 v106, v52, v53
  v_cvt_pk_bf16_f32 v107, v54, v55
  v_cvt_pk_bf16_f32 v108, v56, v57
  s_add_u32 s28, s35, 11534336
  s_add_u32 s29, s36, 13631488
  buffer_store_dwordx4 v[104:107], v102, s[8:11], s28 offen sc1
  buffer_store_dword v108, v103, s[8:11], s29 offen sc1
  s_waitcnt vmcnt(0)
  s_barrier
  s_cmp_eq_u32 s3, 0
  s_cbranch_scc0 P2_NOSIG
  s_lshl_b32 s28, s33, 12
  s_lshl_b32 s29, s32, 7
  s_add_u32 s28, s28, s29
  s_add_u32 s28, s28, 17858560
  s_mov_b64 exec, 1
  v_mov_b32 v12, 0
  v_mov_b32 v13, 1
  buffer_store_dword v13, v12, s[8:11], s28 offen sc1
  s_mov_b64 exec, -1
P2_NOSIG:
  s_branch P3_START
P2_SLOW:
  s_waitcnt lgkmcnt(0)
  v_subrev_u32 v5, 151552, v5
  v_subrev_u32 v6, 151552, v6
  v_subrev_u32 v7, 151552, v7
  v_mov_b32 v111, 0xff800000
  v_mov_b32 v112, v5
  v_mov_b32 v113, v6
  v_mov_b32 v114, v7
  s_mov_b32 s34, 0
P2_SL0:
  ds_read_b128 v[68:71], v112
  ds_read_b32 v74, v113 offset:16384
  s_waitcnt lgkmcnt(0)
  v_mfma_f32_32x32x16_bf16 v[16:31], v[68:71], v[8:11], 0
  v_mfma_f32_32x32x8_bf16 v[16:31], v[74:75], v[12:13], v[16:31]
  s_nop 7
  s_nop 7
  v_max3_f32 v111, v111, v16, v17
  v_max3_f32 v111, v111, v18, v19
  v_max3_f32 v111, v111, v20, v21
  v_max3_f32 v111, v111, v22, v23
  v_max3_f32 v111, v111, v24, v25
  v_max3_f32 v111, v111, v26, v27
  v_max3_f32 v111, v111, v28, v29
  v_max3_f32 v111, v111, v30, v31
  s_add_u32 s34, s34, 1
  s_and_b32 s28, s34, 15
  s_cmp_eq_u32 s28, 0
  s_mov_b32 s29, 1024
  s_mov_b32 s30, 128
  s_mov_b32 s31, 1216
  s_cbranch_scc0 P2_SLA0
  s_mov_b32 s29, 22528
  s_mov_b32 s30, 35968
  s_mov_b32 s31, 19648
P2_SLA0:
  v_add_u32 v112, s29, v112
  v_add_u32 v113, s30, v113
  v_add_u32 v114, s31, v114
  s_cmp_lt_u32 s34, 64
  s_cbranch_scc1 P2_SL0
  v_mov_b32 v115, v111
  s_nop 1
  v_permlane32_swap_b32 v111, v115
  s_nop 1
  v_max_f32 v111, v111, v115
  v_sub_f32 v128, 0, v111
  v_sub_f32 v129, 0, v111
  v_sub_f32 v130, 0, v111
  v_sub_f32 v131, 0, v111
  v_sub_f32 v132, 0, v111
  v_sub_f32 v133, 0, v111
  v_sub_f32 v134, 0, v111
  v_sub_f32 v135, 0, v111
  v_sub_f32 v136, 0, v111
  v_sub_f32 v137, 0, v111
  v_sub_f32 v138, 0, v111
  v_sub_f32 v139, 0, v111
  v_sub_f32 v140, 0, v111
  v_sub_f32 v141, 0, v111
  v_sub_f32 v142, 0, v111
  v_sub_f32 v143, 0, v111
  v_mov_b32 v112, v5
  v_mov_b32 v113, v6
  v_mov_b32 v114, v7
  s_mov_b32 s34, 0
  v_mov_b32 v48, 0
  v_mov_b32 v49, 0
  v_mov_b32 v50, 0
  v_mov_b32 v51, 0
  v_mov_b32 v52, 0
  v_mov_b32 v53, 0
  v_mov_b32 v54, 0
  v_mov_b32 v55, 0
  v_mov_b32 v56, 0
  v_mov_b32 v57, 0
  v_mov_b32 v58, 0
  v_mov_b32 v59, 0
  v_mov_b32 v60, 0
  v_mov_b32 v61, 0
  v_mov_b32 v62, 0
  v_mov_b32 v63, 0
P2_SL1:
  ds_read_b128 v[68:71], v112
  ds_read_b32 v74, v113 offset:16384
  ds_read_b128 v[76:79], v114 offset:18432
  ds_read_b128 v[80:83], v114 offset:19040
  s_waitcnt lgkmcnt(0)
  v_mfma_f32_32x32x16_bf16 v[16:31], v[68:71], v[8:11], v[128:143]
  v_mfma_f32_32x32x8_bf16 v[16:31], v[74:75], v[12:13], v[16:31]
  s_nop 7
  s_nop 7
  v_exp_f32 v16, v16
  v_exp_f32 v17, v17
  v_exp_f32 v18, v18
  v_exp_f32 v19, v19
  v_exp_f32 v20, v20
  v_exp_f32 v21, v21
  v_exp_f32 v22, v22
  v_exp_f32 v23, v23
  v_exp_f32 v24, v24
  v_exp_f32 v25, v25
  v_exp_f32 v26, v26
  v_exp_f32 v27, v27
  v_exp_f32 v28, v28
  v_exp_f32 v29, v29
  v_exp_f32 v30, v30
  v_exp_f32 v31, v31
  s_nop 1
  v_smfmac_f32_32x32x32_bf16 v[48:63], v[76:79], v[16:23], v14
  v_smfmac_f32_32x32x32_bf16 v[48:63], v[80:83], v[24:31], v14
  s_add_u32 s34, s34, 1
  s_and_b32 s28, s34, 15
  s_cmp_eq_u32 s28, 0
  s_mov_b32 s29, 1024
  s_mov_b32 s30, 128
  s_mov_b32 s31, 1216
  s_cbranch_scc0 P2_SLA1
  s_mov_b32 s29, 22528
  s_mov_b32 s30, 35968
  s_mov_b32 s31, 19648
P2_SLA1:
  v_add_u32 v112, s29, v112
  v_add_u32 v113, s30, v113
  v_add_u32 v114, s31, v114
  s_cmp_lt_u32 s34, 64
  s_cbranch_scc1 P2_SL1
  s_nop 7
  s_nop 7
  s_branch P2_NORM
P3_START:
  s_and_b32 s28, s2, 7
  s_lshr_b32 s24, s28, 2
  s_lshr_b32 s29, s2, 3
  s_and_b32 s28, s28, 3
  s_lshl_b32 s28, s28, 2
  s_and_b32 s30, s29, 3
  s_add_u32 s25, s28, s30
  s_lshr_b32 s34, s29, 2
  s_lshl_b32 s30, s30, 1
  s_add_u32 s35, s34, s30
  s_and_b32 s35, s35, 7
  s_cmp_ge_u32 s3, 4
  s_cbranch_scc0 P3_COMPUTE
  s_setprio 1
  s_cmp_ge_u32 s3, 6
  s_cbranch_scc1 P3_OLOAD
  s_sub_u32 s63, s3, 4
  s_cmp_eq_u32 s24, 0
  s_cselect_b32 s4, s44, s50
  s_cselect_b32 s5, s45, s51
  s_mov_b32 s12, s4
  s_mov_b32 s13, s5
  s_mov_b32 s14, 0xa2000
  s_mov_b32 s15, 0x20000
  s_mov_b32 s71, s35
  s_mul_i32 s59, s34, 144
  s_mul_i32 s60, s63, 5120
  s_mul_i32 s61, s63, 320
  v_add_u32 v12, s61, v0
  v_add_u32 v12, 0, v12
  v_mul_u32_u24 v13, 6554, v12
  v_lshrrev_b32 v13, 16, v13
  v_mul_u32_u24 v14, 10, v13
  v_sub_u32 v14, v12, v14
  v_min_u32 v14, 8, v14
  v_lshlrev_b32 v14, 4, v14
  v_bfe_u32 v15, v13, 4, 1
  v_bfe_u32 v5, v13, 3, 1
  v_and_b32 v6, 1, v13
  v_lshl_add_u32 v5, v5, 1, v6
  v_bfe_u32 v6, v13, 1, 2
  v_bfe_u32 v10, v13, 5, 1
  v_mul_u32_u24 v7, 72, v5
  v_mul_u32_u24 v8, 36, v15
  v_mul_u32_u24 v9, 288, v10
  v_add3_u32 v7, v7, v8, v9
  v_lshrrev_b32 v8, 1, v6
  v_mul_u32_u24 v8, 18, v8
  v_and_b32 v9, 1, v6
  v_add3_u32 v7, v7, v8, v9
  v_add_u32 v7, 16, v7
  v_mul_u32_u24 v7, 1152, v7
  v_add_u32 v21, v7, v14
  s_add_u32 m0, s60, 81920
  v_lshrrev_b32 v7, 1, v5
  buffer_load_dwordx4 v21, s[12:15], s59 offen lds
  v_mul_u32_u24 v7, 18, v7
  v_lshl_add_u32 v7, v15, 3, v7
  v_and_b32 v8, 1, v5
  v_lshl_add_u32 v7, v8, 2, v7
  v_add_u32 v7, v7, v6
  v_mul_u32_u24 v8, 36, v10
  v_add_u32 v7, v7, v8
  v_mul_u32_u24 v7, 1152, v7
  v_add_u32 v16, v7, v14
  v_add_u32 v12, s61, v0
  v_add_u32 v12, 64, v12
  v_mul_u32_u24 v13, 6554, v12
  v_lshrrev_b32 v13, 16, v13
  v_mul_u32_u24 v14, 10, v13
  v_sub_u32 v14, v12, v14
  v_min_u32 v14, 8, v14
  v_lshlrev_b32 v14, 4, v14
  v_bfe_u32 v15, v13, 4, 1
  v_bfe_u32 v5, v13, 3, 1
  v_and_b32 v6, 1, v13
  v_lshl_add_u32 v5, v5, 1, v6
  v_bfe_u32 v6, v13, 1, 2
  v_bfe_u32 v10, v13, 5, 1
  v_mul_u32_u24 v7, 72, v5
  v_mul_u32_u24 v8, 36, v15
  v_mul_u32_u24 v9, 288, v10
  v_add3_u32 v7, v7, v8, v9
  v_lshrrev_b32 v8, 1, v6
  v_mul_u32_u24 v8, 18, v8
  v_and_b32 v9, 1, v6
  v_add3_u32 v7, v7, v8, v9
  v_add_u32 v7, 16, v7
  v_mul_u32_u24 v7, 1152, v7
  v_add_u32 v21, v7, v14
  s_add_u32 m0, s60, 82944
  v_lshrrev_b32 v7, 1, v5
  buffer_load_dwordx4 v21, s[12:15], s59 offen lds
  v_mul_u32_u24 v7, 18, v7
  v_lshl_add_u32 v7, v15, 3, v7
  v_and_b32 v8, 1, v5
  v_lshl_add_u32 v7, v8, 2, v7
  v_add_u32 v7, v7, v6
  v_mul_u32_u24 v8, 36, v10
  v_add_u32 v7, v7, v8
  v_mul_u32_u24 v7, 1152, v7
  v_add_u32 v17, v7, v14
  v_add_u32 v12, s61, v0
  v_add_u32 v12, 128, v12
  v_mul_u32_u24 v13, 6554, v12
  v_lshrrev_b32 v13, 16, v13
  v_mul_u32_u24 v14, 10, v13
  v_sub_u32 v14, v12, v14
  v_min_u32 v14, 8, v14
  v_lshlrev_b32 v14, 4, v14
  v_bfe_u32 v15, v13, 4, 1
  v_bfe_u32 v5, v13, 3, 1
  v_and_b32 v6, 1, v13
  v_lshl_add_u32 v5, v5, 1, v6
  v_bfe_u32 v6, v13, 1, 2
  v_bfe_u32 v10, v13, 5, 1
  v_mul_u32_u24 v7, 72, v5
  v_mul_u32_u24 v8, 36, v15
  v_mul_u32_u24 v9, 288, v10
  v_add3_u32 v7, v7, v8, v9
  v_lshrrev_b32 v8, 1, v6
  v_mul_u32_u24 v8, 18, v8
  v_and_b32 v9, 1, v6
  v_add3_u32 v7, v7, v8, v9
  v_add_u32 v7, 16, v7
  v_mul_u32_u24 v7, 1152, v7
  v_add_u32 v21, v7, v14
  s_add_u32 m0, s60, 83968
  v_lshrrev_b32 v7, 1, v5
  buffer_load_dwordx4 v21, s[12:15], s59 offen lds
  v_mul_u32_u24 v7, 18, v7
  v_lshl_add_u32 v7, v15, 3, v7
  v_and_b32 v8, 1, v5
  v_lshl_add_u32 v7, v8, 2, v7
  v_add_u32 v7, v7, v6
  v_mul_u32_u24 v8, 36, v10
  v_add_u32 v7, v7, v8
  v_mul_u32_u24 v7, 1152, v7
  v_add_u32 v18, v7, v14
  v_add_u32 v12, s61, v0
  v_add_u32 v12, 192, v12
  v_mul_u32_u24 v13, 6554, v12
  v_lshrrev_b32 v13, 16, v13
  v_mul_u32_u24 v14, 10, v13
  v_sub_u32 v14, v12, v14
  v_min_u32 v14, 8, v14
  v_lshlrev_b32 v14, 4, v14
  v_bfe_u32 v15, v13, 4, 1
  v_bfe_u32 v5, v13, 3, 1
  v_and_b32 v6, 1, v13
  v_lshl_add_u32 v5, v5, 1, v6
  v_bfe_u32 v6, v13, 1, 2
  v_bfe_u32 v10, v13, 5, 1
  v_mul_u32_u24 v7, 72, v5
  v_mul_u32_u24 v8, 36, v15
  v_mul_u32_u24 v9, 288, v10
  v_add3_u32 v7, v7, v8, v9
  v_lshrrev_b32 v8, 1, v6
  v_mul_u32_u24 v8, 18, v8
  v_and_b32 v9, 1, v6
  v_add3_u32 v7, v7, v8, v9
  v_add_u32 v7, 16, v7
  v_mul_u32_u24 v7, 1152, v7
  v_add_u32 v21, v7, v14
  s_add_u32 m0, s60, 84992
  v_lshrrev_b32 v7, 1, v5
  buffer_load_dwordx4 v21, s[12:15], s59 offen lds
  v_mul_u32_u24 v7, 18, v7
  v_lshl_add_u32 v7, v15, 3, v7
  v_and_b32 v8, 1, v5
  v_lshl_add_u32 v7, v8, 2, v7
  v_add_u32 v7, v7, v6
  v_mul_u32_u24 v8, 36, v10
  v_add_u32 v7, v7, v8
  v_mul_u32_u24 v7, 1152, v7
  v_add_u32 v19, v7, v14
  v_add_u32 v12, s61, v0
  v_add_u32 v12, 256, v12
  v_mul_u32_u24 v13, 6554, v12
  v_lshrrev_b32 v13, 16, v13
  v_mul_u32_u24 v14, 10, v13
  v_sub_u32 v14, v12, v14
  v_min_u32 v14, 8, v14
  v_lshlrev_b32 v14, 4, v14
  v_bfe_u32 v15, v13, 4, 1
  v_bfe_u32 v5, v13, 3, 1
  v_and_b32 v6, 1, v13
  v_lshl_add_u32 v5, v5, 1, v6
  v_bfe_u32 v6, v13, 1, 2
  v_bfe_u32 v10, v13, 5, 1
  v_mul_u32_u24 v7, 72, v5
  v_mul_u32_u24 v8, 36, v15
  v_mul_u32_u24 v9, 288, v10
  v_add3_u32 v7, v7, v8, v9
  v_lshrrev_b32 v8, 1, v6
  v_mul_u32_u24 v8, 18, v8
  v_and_b32 v9, 1, v6
  v_add3_u32 v7, v7, v8, v9
  v_add_u32 v7, 16, v7
  v_mul_u32_u24 v7, 1152, v7
  v_add_u32 v21, v7, v14
  s_add_u32 m0, s60, 86016
  v_lshrrev_b32 v7, 1, v5
  buffer_load_dwordx4 v21, s[12:15], s59 offen lds
  v_mul_u32_u24 v7, 18, v7
  v_lshl_add_u32 v7, v15, 3, v7
  v_and_b32 v8, 1, v5
  v_lshl_add_u32 v7, v8, 2, v7
  v_add_u32 v7, v7, v6
  v_mul_u32_u24 v8, 36, v10
  v_add_u32 v7, v7, v8
  v_mul_u32_u24 v7, 1152, v7
  v_add_u32 v20, v7, v14
  s_mov_b32 s39, 0
P3_WPRE:
  s_mul_i32 s28, s35, 82944
  s_add_u32 s28, s28, s59
  s_mul_i32 s29, s35, 10240
  s_add_u32 s29, s29, s60
  s_add_u32 s35, s35, 1
  s_and_b32 s35, s35, 7
  s_add_u32 m0, s29, 0
  s_nop 0
  buffer_load_dwordx4 v16, s[12:15], s28 offen lds
  s_add_u32 m0, s29, 1024
  s_nop 0
  buffer_load_dwordx4 v17, s[12:15], s28 offen lds
  s_add_u32 m0, s29, 2048
  s_nop 0
  buffer_load_dwordx4 v18, s[12:15], s28 offen lds
  s_add_u32 m0, s29, 3072
  s_nop 0
  buffer_load_dwordx4 v19, s[12:15], s28 offen lds
  s_add_u32 m0, s29, 4096
  s_nop 0
  buffer_load_dwordx4 v20, s[12:15], s28 offen lds
  s_add_u32 s39, s39, 1
  s_cmp_lt_u32 s39, 3
  s_cbranch_scc1 P3_WPRE
  s_mov_b32 s72, s71
  s_sub_u32 s63, s3, 4
  s_cmp_eq_u32 s24, 0
  s_mov_b32 s70, 11534336
  s_cselect_b32 s70, s70, 14680064
  s_lshl_b32 s28, s25, 3
  s_lshl_b32 s29, s63, 1
  s_add_u32 s28, s28, s29
  s_mul_i32 s28, s28, 16384
  s_add_u32 s38, s28, s70
  s_lshl_b32 s58, s63, 12
  s_add_u32 s58, s58, 92160
  s_mov_b32 s37, 0
  s_mov_b32 s31, 1600000
  v_mov_b32 v12, 163336
P3_PLW_L:
  ds_read_b32 v14, v12
  s_waitcnt lgkmcnt(0)
  v_readfirstlane_b32 s4, v14
  s_nop 3
  s_cmp_eq_u32 s4, 1
  s_cbranch_scc1 P3_PLW_D
  s_sub_u32 s31, s31, 1
  s_cmp_lg_u32 s31, 0
  s_cbranch_scc1 P3_PLW_L
P3_PLW_D:
  s_lshl_b32 s28, s25, 2
  s_add_u32 s28, s28, s63
  s_lshl_b32 s28, s28, 12
  s_add_u32 s28, s28, s70
  s_add_u32 s28, s28, 2097152
  s_add_u32 s30, s28, 2048
  s_add_u32 s29, s37, s58
  s_mov_b32 m0, s29
  s_add_u32 s37, s37, 16384
  buffer_load_dwordx4 v1, s[8:11], s28 offen sc1 lds
  buffer_load_dwordx4 v1, s[8:11], s28 offen offset:1024 sc1 lds
  s_add_u32 m0, s29, 2048
  s_and_b32 s37, s37, 65535
  buffer_load_dwordx4 v1, s[8:11], s30 offen sc1 lds
  buffer_load_dwordx4 v1, s[8:11], s30 offen offset:1024 sc1 lds
  s_lshl_b32 s28, s72, 11
  s_add_u32 s28, s28, s38
  s_add_u32 s30, s28, 16384
  s_add_u32 s72, s72, 1
  s_and_b32 s72, s72, 7
  s_add_u32 s29, s37, s58
  s_mov_b32 m0, s29
  s_add_u32 s37, s37, 16384
  buffer_load_dwordx4 v1, s[8:11], s28 offen sc1 lds
  buffer_load_dwordx4 v1, s[8:11], s28 offen offset:1024 sc1 lds
  s_add_u32 m0, s29, 2048
  s_and_b32 s37, s37, 65535
  buffer_load_dwordx4 v1, s[8:11], s30 offen sc1 lds
  buffer_load_dwordx4 v1, s[8:11], s30 offen offset:1024 sc1 lds
  s_lshl_b32 s28, s72, 11
  s_add_u32 s28, s28, s38
  s_add_u32 s30, s28, 16384
  s_add_u32 s72, s72, 1
  s_and_b32 s72, s72, 7
  s_add_u32 s29, s37, s58
  s_mov_b32 m0, s29
  s_add_u32 s37, s37, 16384
  buffer_load_dwordx4 v1, s[8:11], s28 offen sc1 lds
  buffer_load_dwordx4 v1, s[8:11], s28 offen offset:1024 sc1 lds
  s_add_u32 m0, s29, 2048
  s_and_b32 s37, s37, 65535
  buffer_load_dwordx4 v1, s[8:11], s30 offen sc1 lds
  buffer_load_dwordx4 v1, s[8:11], s30 offen offset:1024 sc1 lds
  s_waitcnt vmcnt(8)
  s_barrier
  s_mul_i32 s28, s35, 82944
  s_add_u32 s28, s28, s59
  s_mul_i32 s29, s35, 10240
  s_add_u32 s29, s29, s60
  s_add_u32 s35, s35, 1
  s_and_b32 s35, s35, 7
  s_add_u32 m0, s29, 0
  s_nop 0
  buffer_load_dwordx4 v16, s[12:15], s28 offen lds
  s_add_u32 m0, s29, 1024
  s_nop 0
  buffer_load_dwordx4 v17, s[12:15], s28 offen lds
  s_add_u32 m0, s29, 2048
  s_nop 0
  buffer_load_dwordx4 v18, s[12:15], s28 offen lds
  s_add_u32 m0, s29, 3072
  s_nop 0
  buffer_load_dwordx4 v19, s[12:15], s28 offen lds
  s_add_u32 m0, s29, 4096
  s_nop 0
  buffer_load_dwordx4 v20, s[12:15], s28 offen lds
  s_lshl_b32 s28, s72, 11
  s_add_u32 s28, s28, s38
  s_add_u32 s30, s28, 16384
  s_add_u32 s72, s72, 1
  s_and_b32 s72, s72, 7
  s_add_u32 s29, s37, s58
  s_mov_b32 m0, s29
  s_add_u32 s37, s37, 16384
  buffer_load_dwordx4 v1, s[8:11], s28 offen sc1 lds
  buffer_load_dwordx4 v1, s[8:11], s28 offen offset:1024 sc1 lds
  s_add_u32 m0, s29, 2048
  s_and_b32 s37, s37, 65535
  buffer_load_dwordx4 v1, s[8:11], s30 offen sc1 lds
  buffer_load_dwordx4 v1, s[8:11], s30 offen offset:1024 sc1 lds
  s_waitcnt vmcnt(13)
  s_barrier
  s_mul_i32 s28, s35, 82944
  s_add_u32 s28, s28, s59
  s_mul_i32 s29, s35, 10240
  s_add_u32 s29, s29, s60
  s_add_u32 s35, s35, 1
  s_and_b32 s35, s35, 7
  s_add_u32 m0, s29, 0
  s_nop 0
  buffer_load_dwordx4 v16, s[12:15], s28 offen lds
  s_add_u32 m0, s29, 1024
  s_nop 0
  buffer_load_dwordx4 v17, s[12:15], s28 offen lds
  s_add_u32 m0, s29, 2048
  s_nop 0
  buffer_load_dwordx4 v18, s[12:15], s28 offen lds
  s_add_u32 m0, s29, 3072
  s_nop 0
  buffer_load_dwordx4 v19, s[12:15], s28 offen lds
  s_add_u32 m0, s29, 4096
  s_nop 0
  buffer_load_dwordx4 v20, s[12:15], s28 offen lds
  s_lshl_b32 s28, s72, 11
  s_add_u32 s28, s28, s38
  s_add_u32 s30, s28, 16384
  s_add_u32 s72, s72, 1
  s_and_b32 s72, s72, 7
  s_add_u32 s29, s37, s58
  s_mov_b32 m0, s29
  s_add_u32 s37, s37, 16384
  buffer_load_dwordx4 v1, s[8:11], s28 offen sc1 lds
  buffer_load_dwordx4 v1, s[8:11], s28 offen offset:1024 sc1 lds
  s_add_u32 m0, s29, 2048
  s_and_b32 s37, s37, 65535
  buffer_load_dwordx4 v1, s[8:11], s30 offen sc1 lds
  buffer_load_dwordx4 v1, s[8:11], s30 offen offset:1024 sc1 lds
  s_waitcnt vmcnt(18)
  s_barrier
  s_mul_i32 s28, s35, 82944
  s_add_u32 s28, s28, s59
  s_mul_i32 s29, s35, 10240
  s_add_u32 s29, s29, s60
  s_add_u32 s35, s35, 1
  s_and_b32 s35, s35, 7
  s_add_u32 m0, s29, 0
  s_nop 0
  buffer_load_dwordx4 v16, s[12:15], s28 offen lds
  s_add_u32 m0, s29, 1024
  s_nop 0
  buffer_load_dwordx4 v17, s[12:15], s28 offen lds
  s_add_u32 m0, s29, 2048
  s_nop 0
  buffer_load_dwordx4 v18, s[12:15], s28 offen lds
  s_add_u32 m0, s29, 3072
  s_nop 0
  buffer_load_dwordx4 v19, s[12:15], s28 offen lds
  s_add_u32 m0, s29, 4096
  s_nop 0
  buffer_load_dwordx4 v20, s[12:15], s28 offen lds
  s_lshl_b32 s28, s72, 11
  s_add_u32 s28, s28, s38
  s_add_u32 s30, s28, 16384
  s_add_u32 s72, s72, 1
  s_and_b32 s72, s72, 7
  s_add_u32 s29, s37, s58
  s_mov_b32 m0, s29
  s_add_u32 s37, s37, 16384
  buffer_load_dwordx4 v1, s[8:11], s28 offen sc1 lds
  buffer_load_dwordx4 v1, s[8:11], s28 offen offset:1024 sc1 lds
  s_add_u32 m0, s29, 2048
  s_and_b32 s37, s37, 65535
  buffer_load_dwordx4 v1, s[8:11], s30 offen sc1 lds
  buffer_load_dwordx4 v1, s[8:11], s30 offen offset:1024 sc1 lds
  s_waitcnt vmcnt(18)
  s_barrier
  s_mul_i32 s28, s35, 82944
  s_add_u32 s28, s28, s59
  s_mul_i32 s29, s35, 10240
  s_add_u32 s29, s29, s60
  s_add_u32 s35, s35, 1
  s_and_b32 s35, s35, 7
  s_add_u32 m0, s29, 0
  s_nop 0
  buffer_load_dwordx4 v16, s[12:15], s28 offen lds
  s_add_u32 m0, s29, 1024
  s_nop 0
  buffer_load_dwordx4 v17, s[12:15], s28 offen lds
  s_add_u32 m0, s29, 2048
  s_nop 0
  buffer_load_dwordx4 v18, s[12:15], s28 offen lds
  s_add_u32 m0, s29, 3072
  s_nop 0
  buffer_load_dwordx4 v19, s[12:15], s28 offen lds
  s_add_u32 m0, s29, 4096
  s_nop 0
  buffer_load_dwordx4 v20, s[12:15], s28 offen lds
  s_lshl_b32 s28, s72, 11
  s_add_u32 s28, s28, s38
  s_add_u32 s30, s28, 16384
  s_add_u32 s72, s72, 1
  s_and_b32 s72, s72, 7
  s_add_u32 s29, s37, s58
  s_mov_b32 m0, s29
  s_add_u32 s37, s37, 16384
  buffer_load_dwordx4 v1, s[8:11], s28 offen sc1 lds
  buffer_load_dwordx4 v1, s[8:11], s28 offen offset:1024 sc1 lds
  s_add_u32 m0, s29, 2048
  s_and_b32 s37, s37, 65535
  buffer_load_dwordx4 v1, s[8:11], s30 offen sc1 lds
  buffer_load_dwordx4 v1, s[8:11], s30 offen offset:1024 sc1 lds
  s_waitcnt vmcnt(18)
  s_barrier
  s_mul_i32 s28, s35, 82944
  s_add_u32 s28, s28, s59
  s_mul_i32 s29, s35, 10240
  s_add_u32 s29, s29, s60
  s_add_u32 s35, s35, 1
  s_and_b32 s35, s35, 7
  s_add_u32 m0, s29, 0
  s_nop 0
  buffer_load_dwordx4 v16, s[12:15], s28 offen lds
  s_add_u32 m0, s29, 1024
  s_nop 0
  buffer_load_dwordx4 v17, s[12:15], s28 offen lds
  s_add_u32 m0, s29, 2048
  s_nop 0
  buffer_load_dwordx4 v18, s[12:15], s28 offen lds
  s_add_u32 m0, s29, 3072
  s_nop 0
  buffer_load_dwordx4 v19, s[12:15], s28 offen lds
  s_add_u32 m0, s29, 4096
  s_nop 0
  buffer_load_dwordx4 v20, s[12:15], s28 offen lds
  s_lshl_b32 s28, s72, 11
  s_add_u32 s28, s28, s38
  s_add_u32 s30, s28, 16384
  s_add_u32 s72, s72, 1
  s_and_b32 s72, s72, 7
  s_add_u32 s29, s37, s58
  s_mov_b32 m0, s29
  s_add_u32 s37, s37, 16384
  buffer_load_dwordx4 v1, s[8:11], s28 offen sc1 lds
  buffer_load_dwordx4 v1, s[8:11], s28 offen offset:1024 sc1 lds
  s_add_u32 m0, s29, 2048
  s_and_b32 s37, s37, 65535
  buffer_load_dwordx4 v1, s[8:11], s30 offen sc1 lds
  buffer_load_dwordx4 v1, s[8:11], s30 offen offset:1024 sc1 lds
  s_waitcnt vmcnt(18)
  s_barrier
  s_lshl_b32 s28, s72, 11
  s_add_u32 s28, s28, s38
  s_add_u32 s30, s28, 16384
  s_add_u32 s72, s72, 1
  s_and_b32 s72, s72, 7
  s_add_u32 s29, s37, s58
  s_mov_b32 m0, s29
  s_add_u32 s37, s37, 16384
  buffer_load_dwordx4 v1, s[8:11], s28 offen sc1 lds
  buffer_load_dwordx4 v1, s[8:11], s28 offen offset:1024 sc1 lds
  s_add_u32 m0, s29, 2048
  s_and_b32 s37, s37, 65535
  buffer_load_dwordx4 v1, s[8:11], s30 offen sc1 lds
  buffer_load_dwordx4 v1, s[8:11], s30 offen offset:1024 sc1 lds
  s_waitcnt vmcnt(13)
  s_barrier
  s_waitcnt vmcnt(4)
  s_barrier
  s_waitcnt vmcnt(0)
  s_barrier
  s_endpgm
P3_OLOAD:
  s_cmp_eq_u32 s3, 6
  s_cbranch_scc0 P3_PW
  v_and_b32 v13, 31, v0
  v_lshlrev_b32 v13, 7, v13
  s_lshr_b32 s28, s25, 1
  s_lshl_b32 s28, s28, 12
  s_add_u32 s28, s28, 17858560
  s_mov_b32 s31, 200000
P3_PF_L:
  buffer_load_dword v12, v13, s[8:11], s28 offen sc1
  s_waitcnt vmcnt(0)
  v_cmp_ne_u32 vcc, 1, v12
  s_nop 3
  s_cmp_eq_u64 vcc, 0
  s_cbranch_scc1 P3_PF_D
  s_sub_u32 s31, s31, 1
  s_cmp_lg_u32 s31, 0
  s_cbranch_scc1 P3_PF_L
P3_PF_D:
  s_waitcnt vmcnt(0)
  v_mov_b32 v12, 163336
  v_mov_b32 v14, 1
  ds_write_b32 v12, v14
  s_branch P3_PD
P3_PW:
  s_mov_b32 s31, 1600000
  v_mov_b32 v12, 163336
P3_PL_L:
  ds_read_b32 v14, v12
  s_waitcnt lgkmcnt(0)
  v_readfirstlane_b32 s4, v14
  s_nop 3
  s_cmp_eq_u32 s4, 1
  s_cbranch_scc1 P3_PL_D
  s_sub_u32 s31, s31, 1
  s_cmp_lg_u32 s31, 0
  s_cbranch_scc1 P3_PL_L
P3_PL_D:
P3_PD:
  s_mov_b32 s72, s35
  s_sub_u32 s63, s3, 4
  s_cmp_eq_u32 s24, 0
  s_mov_b32 s70, 11534336
  s_cselect_b32 s70, s70, 14680064
  s_lshl_b32 s28, s25, 3
  s_lshl_b32 s29, s63, 1
  s_add_u32 s28, s28, s29
  s_mul_i32 s28, s28, 16384
  s_add_u32 s38, s28, s70
  s_lshl_b32 s58, s63, 12
  s_add_u32 s58, s58, 92160
  s_mov_b32 s37, 0
  s_lshl_b32 s28, s25, 2
  s_add_u32 s28, s28, s63
  s_lshl_b32 s28, s28, 12
  s_add_u32 s28, s28, s70
  s_add_u32 s28, s28, 2097152
  s_add_u32 s30, s28, 2048
  s_add_u32 s29, s37, s58
  s_mov_b32 m0, s29
  s_add_u32 s37, s37, 16384
  buffer_load_dwordx4 v1, s[8:11], s28 offen sc1 lds
  buffer_load_dwordx4 v1, s[8:11], s28 offen offset:1024 sc1 lds
  s_add_u32 m0, s29, 2048
  s_and_b32 s37, s37, 65535
  buffer_load_dwordx4 v1, s[8:11], s30 offen sc1 lds
  buffer_load_dwordx4 v1, s[8:11], s30 offen offset:1024 sc1 lds
  s_lshl_b32 s28, s72, 11
  s_add_u32 s28, s28, s38
  s_add_u32 s30, s28, 16384
  s_add_u32 s72, s72, 1
  s_and_b32 s72, s72, 7
  s_add_u32 s29, s37, s58
  s_mov_b32 m0, s29
  s_add_u32 s37, s37, 16384
  buffer_load_dwordx4 v1, s[8:11], s28 offen sc1 lds
  buffer_load_dwordx4 v1, s[8:11], s28 offen offset:1024 sc1 lds
  s_add_u32 m0, s29, 2048
  s_and_b32 s37, s37, 65535
  buffer_load_dwordx4 v1, s[8:11], s30 offen sc1 lds
  buffer_load_dwordx4 v1, s[8:11], s30 offen offset:1024 sc1 lds
  s_lshl_b32 s28, s72, 11
  s_add_u32 s28, s28, s38
  s_add_u32 s30, s28, 16384
  s_add_u32 s72, s72, 1
  s_and_b32 s72, s72, 7
  s_add_u32 s29, s37, s58
  s_mov_b32 m0, s29
  s_add_u32 s37, s37, 16384
  buffer_load_dwordx4 v1, s[8:11], s28 offen sc1 lds
  buffer_load_dwordx4 v1, s[8:11], s28 offen offset:1024 sc1 lds
  s_add_u32 m0, s29, 2048
  s_and_b32 s37, s37, 65535
  buffer_load_dwordx4 v1, s[8:11], s30 offen sc1 lds
  buffer_load_dwordx4 v1, s[8:11], s30 offen offset:1024 sc1 lds
  s_waitcnt vmcnt(8)
  s_barrier
  s_lshl_b32 s28, s72, 11
  s_add_u32 s28, s28, s38
  s_add_u32 s30, s28, 16384
  s_add_u32 s72, s72, 1
  s_and_b32 s72, s72, 7
  s_add_u32 s29, s37, s58
  s_mov_b32 m0, s29
  s_add_u32 s37, s37, 16384
  buffer_load_dwordx4 v1, s[8:11], s28 offen sc1 lds
  buffer_load_dwordx4 v1, s[8:11], s28 offen offset:1024 sc1 lds
  s_add_u32 m0, s29, 2048
  s_and_b32 s37, s37, 65535
  buffer_load_dwordx4 v1, s[8:11], s30 offen sc1 lds
  buffer_load_dwordx4 v1, s[8:11], s30 offen offset:1024 sc1 lds
  s_waitcnt vmcnt(8)
  s_barrier
  s_lshl_b32 s28, s72, 11
  s_add_u32 s28, s28, s38
  s_add_u32 s30, s28, 16384
  s_add_u32 s72, s72, 1
  s_and_b32 s72, s72, 7
  s_add_u32 s29, s37, s58
  s_mov_b32 m0, s29
  s_add_u32 s37, s37, 16384
  buffer_load_dwordx4 v1, s[8:11], s28 offen sc1 lds
  buffer_load_dwordx4 v1, s[8:11], s28 offen offset:1024 sc1 lds
  s_add_u32 m0, s29, 2048
  s_and_b32 s37, s37, 65535
  buffer_load_dwordx4 v1, s[8:11], s30 offen sc1 lds
  buffer_load_dwordx4 v1, s[8:11], s30 offen offset:1024 sc1 lds
  s_waitcnt vmcnt(8)
  s_barrier
  s_lshl_b32 s28, s72, 11
  s_add_u32 s28, s28, s38
  s_add_u32 s30, s28, 16384
  s_add_u32 s72, s72, 1
  s_and_b32 s72, s72, 7
  s_add_u32 s29, s37, s58
  s_mov_b32 m0, s29
  s_add_u32 s37, s37, 16384
  buffer_load_dwordx4 v1, s[8:11], s28 offen sc1 lds
  buffer_load_dwordx4 v1, s[8:11], s28 offen offset:1024 sc1 lds
  s_add_u32 m0, s29, 2048
  s_and_b32 s37, s37, 65535
  buffer_load_dwordx4 v1, s[8:11], s30 offen sc1 lds
  buffer_load_dwordx4 v1, s[8:11], s30 offen offset:1024 sc1 lds
  s_waitcnt vmcnt(8)
  s_barrier
  s_lshl_b32 s28, s72, 11
  s_add_u32 s28, s28, s38
  s_add_u32 s30, s28, 16384
  s_add_u32 s72, s72, 1
  s_and_b32 s72, s72, 7
  s_add_u32 s29, s37, s58
  s_mov_b32 m0, s29
  s_add_u32 s37, s37, 16384
  buffer_load_dwordx4 v1, s[8:11], s28 offen sc1 lds
  buffer_load_dwordx4 v1, s[8:11], s28 offen offset:1024 sc1 lds
  s_add_u32 m0, s29, 2048
  s_and_b32 s37, s37, 65535
  buffer_load_dwordx4 v1, s[8:11], s30 offen sc1 lds
  buffer_load_dwordx4 v1, s[8:11], s30 offen offset:1024 sc1 lds
  s_waitcnt vmcnt(8)
  s_barrier
  s_lshl_b32 s28, s72, 11
  s_add_u32 s28, s28, s38
  s_add_u32 s30, s28, 16384
  s_add_u32 s72, s72, 1
  s_and_b32 s72, s72, 7
  s_add_u32 s29, s37, s58
  s_mov_b32 m0, s29
  s_add_u32 s37, s37, 16384
  buffer_load_dwordx4 v1, s[8:11], s28 offen sc1 lds
  buffer_load_dwordx4 v1, s[8:11], s28 offen offset:1024 sc1 lds
  s_add_u32 m0, s29, 2048
  s_and_b32 s37, s37, 65535
  buffer_load_dwordx4 v1, s[8:11], s30 offen sc1 lds
  buffer_load_dwordx4 v1, s[8:11], s30 offen offset:1024 sc1 lds
  s_waitcnt vmcnt(8)
  s_barrier
  s_lshl_b32 s28, s72, 11
  s_add_u32 s28, s28, s38
  s_add_u32 s30, s28, 16384
  s_add_u32 s72, s72, 1
  s_and_b32 s72, s72, 7
  s_add_u32 s29, s37, s58
  s_mov_b32 m0, s29
  s_add_u32 s37, s37, 16384
  buffer_load_dwordx4 v1, s[8:11], s28 offen sc1 lds
  buffer_load_dwordx4 v1, s[8:11], s28 offen offset:1024 sc1 lds
  s_add_u32 m0, s29, 2048
  s_and_b32 s37, s37, 65535
  buffer_load_dwordx4 v1, s[8:11], s30 offen sc1 lds
  buffer_load_dwordx4 v1, s[8:11], s30 offen offset:1024 sc1 lds
  s_waitcnt vmcnt(8)
  s_barrier
  s_waitcnt vmcnt(4)
  s_barrier
  s_waitcnt vmcnt(0)
  s_barrier
  s_endpgm
P3_COMPUTE:
  v_lshrrev_b32 v12, 5, v0
  v_bfe_u32 v13, v0, 2, 2
  v_lshl_add_u32 v12, v13, 1, v12
  v_mul_u32_u24 v12, 160, v12
  v_bfe_u32 v13, v0, 4, 1
  v_lshlrev_b32 v14, 5, v13
  v_and_b32 v15, 3, v0
  v_lshlrev_b32 v15, 3, v15
  v_add3_u32 v9, v12, v14, v15
  s_mul_i32 s28, s35, 10240
  v_add_u32 v5, s28, v9
  v_add_u32 v9, 81920, v9
  v_lshlrev_b32 v13, 20, v13
  v_or_b32 v6, v5, v13
  v_or_b32 v10, v9, v13
  s_lshl_b32 s28, s3, 12
  s_add_u32 s28, s28, 92160
  v_bfe_u32 v12, v0, 4, 1
  v_lshlrev_b32 v12, 11, v12
  v_and_b32 v13, 256, v4
  v_and_b32 v14, 15, v0
  v_lshlrev_b32 v14, 4, v14
  v_add3_u32 v12, v12, v13, v14
  v_add_u32 v7, s28, v12
  v_and_b32 v13, 512, v4
  v_add3_u32 v8, v13, v3, s28
  v_mov_b32 v24, 0
  v_mov_b32 v25, 0
  v_mov_b32 v26, 0
  v_mov_b32 v27, 0
  v_mov_b32 v28, 0
  v_mov_b32 v29, 0
  v_mov_b32 v30, 0
  v_mov_b32 v31, 0
  v_mov_b32 v32, 0
  v_mov_b32 v33, 0
  v_mov_b32 v34, 0
  v_mov_b32 v35, 0
  v_mov_b32 v36, 0
  v_mov_b32 v37, 0
  v_mov_b32 v38, 0
  v_mov_b32 v39, 0
  v_mov_b32 v40, 0
  v_mov_b32 v41, 0
  v_mov_b32 v42, 0
  v_mov_b32 v43, 0
  v_mov_b32 v44, 0
  v_mov_b32 v45, 0
  v_mov_b32 v46, 0
  v_mov_b32 v47, 0
  v_mov_b32 v48, 0
  v_mov_b32 v49, 0
  v_mov_b32 v50, 0
  v_mov_b32 v51, 0
  v_mov_b32 v52, 0
  v_mov_b32 v53, 0
  v_mov_b32 v54, 0
  v_mov_b32 v55, 0
  v_mov_b32 v56, 0
  v_mov_b32 v57, 0
  v_mov_b32 v58, 0
  v_mov_b32 v59, 0
  v_mov_b32 v60, 0
  v_mov_b32 v61, 0
  v_mov_b32 v62, 0
  v_mov_b32 v63, 0
  v_mov_b32 v64, 0
  v_mov_b32 v65, 0
  v_mov_b32 v66, 0
  v_mov_b32 v67, 0
  v_mov_b32 v68, 0
  v_mov_b32 v69, 0
  v_mov_b32 v70, 0
  v_mov_b32 v71, 0
  s_mov_b32 s39, 0
  s_mov_b32 s58, 4294918144
  s_mov_b32 s59, 16384
  s_mov_b32 s60, 4294895616
  s_mov_b32 s61, 10240
  s_mov_b32 s16, s52
  s_mov_b32 s17, s53
  s_mov_b32 s18, 0x480000
  s_mov_b32 s19, 0x20000
  s_barrier
  ds_read_b32 v120, v8 offset:0
  ds_read_b32 v121, v8 offset:128
  ds_read_b32 v122, v8 offset:256
  ds_read_b32 v123, v8 offset:384
  ds_read_b64_tr_b16 v[72:73], v9 offset:0
  ds_read_b64_tr_b16 v[74:75], v9 offset:2560
  ds_read_b64_tr_b16 v[76:77], v9 offset:64
  ds_read_b64_tr_b16 v[78:79], v9 offset:2624
  ds_read_b64_tr_b16 v[80:81], v10 offset:128
  ds_read_b64_tr_b16 v[82:83], v10 offset:2688
  s_waitcnt lgkmcnt(6)
  ds_read_b32 v124, v8 offset:1024
  ds_read_b32 v125, v8 offset:1152
  ds_read_b32 v126, v8 offset:1280
  ds_read_b32 v127, v8 offset:1408
  s_waitcnt lgkmcnt(4)
  ds_read_b64_tr_b16 v[84:85], v9 offset:1280
  ds_read_b64_tr_b16 v[86:87], v9 offset:3840
  ds_read_b64_tr_b16 v[88:89], v9 offset:1344
  ds_read_b64_tr_b16 v[90:91], v9 offset:3904
  ds_read_b64_tr_b16 v[92:93], v10 offset:1408
  ds_read_b64_tr_b16 v[94:95], v10 offset:3968
  v_mfma_f32_32x32x16_bf16 v[24:39], v[72:75], v[120:123], v[24:39]
  v_mfma_f32_32x32x16_bf16 v[40:55], v[76:79], v[120:123], v[40:55]
  v_mfma_f32_32x32x16_bf16 v[56:71], v[80:83], v[120:123], v[56:71]
  s_waitcnt lgkmcnt(6)
  ds_read_b32 v128, v8 offset:2048
  ds_read_b32 v129, v8 offset:2176
  ds_read_b32 v130, v8 offset:2304
  ds_read_b32 v131, v8 offset:2432
  s_waitcnt lgkmcnt(4)
  ds_read_b64_tr_b16 v[96:97], v9 offset:5120
  ds_read_b64_tr_b16 v[98:99], v9 offset:7680
  ds_read_b64_tr_b16 v[100:101], v9 offset:5184
  ds_read_b64_tr_b16 v[102:103], v9 offset:7744
  ds_read_b64_tr_b16 v[104:105], v10 offset:5248
  ds_read_b64_tr_b16 v[106:107], v10 offset:7808
  v_mfma_f32_32x32x16_bf16 v[24:39], v[84:87], v[124:127], v[24:39]
  v_mfma_f32_32x32x16_bf16 v[40:55], v[88:91], v[124:127], v[40:55]
  v_mfma_f32_32x32x16_bf16 v[56:71], v[92:95], v[124:127], v[56:71]
  s_waitcnt lgkmcnt(6)
  ds_read_b32 v132, v8 offset:3072
  ds_read_b32 v133, v8 offset:3200
  ds_read_b32 v134, v8 offset:3328
  ds_read_b32 v135, v8 offset:3456
  s_waitcnt lgkmcnt(4)
  ds_read_b64_tr_b16 v[108:109], v9 offset:6400
  ds_read_b64_tr_b16 v[110:111], v9 offset:8960
  ds_read_b64_tr_b16 v[112:113], v9 offset:6464
  ds_read_b64_tr_b16 v[114:115], v9 offset:9024
  ds_read_b64_tr_b16 v[116:117], v10 offset:6528
  ds_read_b64_tr_b16 v[118:119], v10 offset:9088
  v_mfma_f32_32x32x16_bf16 v[24:39], v[96:99], v[128:131], v[24:39]
  v_mfma_f32_32x32x16_bf16 v[40:55], v[100:103], v[128:131], v[40:55]
  v_mfma_f32_32x32x16_bf16 v[56:71], v[104:107], v[128:131], v[56:71]
  s_waitcnt lgkmcnt(0)
  v_mfma_f32_32x32x16_bf16 v[24:39], v[108:111], v[132:135], v[24:39]
  v_mfma_f32_32x32x16_bf16 v[40:55], v[112:115], v[132:135], v[40:55]
  v_mfma_f32_32x32x16_bf16 v[56:71], v[116:119], v[132:135], v[56:71]
  v_add_u32 v7, 16384, v7
  s_mov_b32 s36, 1
  s_barrier
  ds_read_b128 v[120:123], v7 offset:0
  ds_read_b64_tr_b16 v[72:73], v5 offset:0
  ds_read_b64_tr_b16 v[74:75], v5 offset:2560
  ds_read_b64_tr_b16 v[76:77], v5 offset:64
  ds_read_b64_tr_b16 v[78:79], v5 offset:2624
  ds_read_b64_tr_b16 v[80:81], v6 offset:128
  ds_read_b64_tr_b16 v[82:83], v6 offset:2688
  ds_read_b128 v[124:127], v7 offset:512
  ds_read_b64_tr_b16 v[84:85], v5 offset:1280
  ds_read_b64_tr_b16 v[86:87], v5 offset:3840
  ds_read_b64_tr_b16 v[88:89], v5 offset:1344
  ds_read_b64_tr_b16 v[90:91], v5 offset:3904
  ds_read_b64_tr_b16 v[92:93], v6 offset:1408
  ds_read_b64_tr_b16 v[94:95], v6 offset:3968
  .p2align 6
P3_LOOP:
  s_waitcnt lgkmcnt(7)
  v_mfma_f32_32x32x16_bf16 v[24:39], v[72:75], v[120:123], v[24:39]
  ds_read_b128 v[128:131], v7 offset:1024
  ds_read_b64_tr_b16 v[96:97], v5 offset:5120
  ds_read_b64_tr_b16 v[98:99], v5 offset:7680
  v_mfma_f32_32x32x16_bf16 v[40:55], v[76:79], v[120:123], v[40:55]
  ds_read_b64_tr_b16 v[100:101], v5 offset:5184
  ds_read_b64_tr_b16 v[102:103], v5 offset:7744
  v_mfma_f32_32x32x16_bf16 v[56:71], v[80:83], v[120:123], v[56:71]
  ds_read_b64_tr_b16 v[104:105], v6 offset:5248
  ds_read_b64_tr_b16 v[106:107], v6 offset:7808
  s_waitcnt lgkmcnt(7)
  v_mfma_f32_32x32x16_bf16 v[24:39], v[84:87], v[124:127], v[24:39]
  ds_read_b128 v[132:135], v7 offset:1536
  ds_read_b64_tr_b16 v[108:109], v5 offset:6400
  ds_read_b64_tr_b16 v[110:111], v5 offset:8960
  v_mfma_f32_32x32x16_bf16 v[40:55], v[88:91], v[124:127], v[40:55]
  ds_read_b64_tr_b16 v[112:113], v5 offset:6464
  ds_read_b64_tr_b16 v[114:115], v5 offset:9024
  v_mfma_f32_32x32x16_bf16 v[56:71], v[92:95], v[124:127], v[56:71]
  ds_read_b64_tr_b16 v[116:117], v6 offset:6528
  ds_read_b64_tr_b16 v[118:119], v6 offset:9088
  s_waitcnt lgkmcnt(6)
  s_add_u32 s36, s36, 1
  s_cmp_eq_u32 s36, 4
  s_cselect_b32 s28, s58, s59
  s_cselect_b32 s36, 0, s36
  v_add_u32 v7, s28, v7
  s_add_u32 s35, s35, 1
  s_cmp_eq_u32 s35, 8
  s_cselect_b32 s28, s60, s61
  s_cselect_b32 s35, 0, s35
  v_mfma_f32_32x32x16_bf16 v[24:39], v[96:99], v[128:131], v[24:39]
  v_add_u32 v5, s28, v5
  v_add_u32 v6, s28, v6
  s_cmp_eq_u32 s39, 7
  s_cbranch_scc1 P3_NOBAR
  s_barrier
P3_NOBAR:
  ds_read_b128 v[120:123], v7 offset:0
  ds_read_b64_tr_b16 v[72:73], v5 offset:0
  ds_read_b64_tr_b16 v[74:75], v5 offset:2560
  v_mfma_f32_32x32x16_bf16 v[40:55], v[100:103], v[128:131], v[40:55]
  ds_read_b64_tr_b16 v[76:77], v5 offset:64
  ds_read_b64_tr_b16 v[78:79], v5 offset:2624
  v_mfma_f32_32x32x16_bf16 v[56:71], v[104:107], v[128:131], v[56:71]
  ds_read_b64_tr_b16 v[80:81], v6 offset:128
  ds_read_b64_tr_b16 v[82:83], v6 offset:2688
  s_waitcnt lgkmcnt(7)
  v_mfma_f32_32x32x16_bf16 v[24:39], v[108:111], v[132:135], v[24:39]
  ds_read_b128 v[124:127], v7 offset:512
  ds_read_b64_tr_b16 v[84:85], v5 offset:1280
  ds_read_b64_tr_b16 v[86:87], v5 offset:3840
  v_mfma_f32_32x32x16_bf16 v[40:55], v[112:115], v[132:135], v[40:55]
  ds_read_b64_tr_b16 v[88:89], v5 offset:1344
  ds_read_b64_tr_b16 v[90:91], v5 offset:3904
  v_mfma_f32_32x32x16_bf16 v[56:71], v[116:119], v[132:135], v[56:71]
  ds_read_b64_tr_b16 v[92:93], v6 offset:1408
  ds_read_b64_tr_b16 v[94:95], v6 offset:3968
  s_add_u32 s39, s39, 1
  s_cmp_lt_u32 s39, 8
  s_cbranch_scc1 P3_LOOP
  s_waitcnt lgkmcnt(0)
  s_barrier
  s_mul_i32 s28, s3, 5632
  v_and_b32 v12, 31, v0
  v_mul_u32_u24 v12, 176, v12
  v_and_b32 v13, 8, v4
  v_add3_u32 v12, v12, v13, s28
  s_nop 7
  v_cvt_pk_bf16_f32 v72, v24, v25
  v_cvt_pk_bf16_f32 v73, v26, v27
  ds_write_b64 v12, v[72:73] offset:0
  v_cvt_pk_bf16_f32 v74, v28, v29
  v_cvt_pk_bf16_f32 v75, v30, v31
  ds_write_b64 v12, v[74:75] offset:16
  v_cvt_pk_bf16_f32 v76, v32, v33
  v_cvt_pk_bf16_f32 v77, v34, v35
  ds_write_b64 v12, v[76:77] offset:32
  v_cvt_pk_bf16_f32 v78, v36, v37
  v_cvt_pk_bf16_f32 v79, v38, v39
  ds_write_b64 v12, v[78:79] offset:48
  v_cvt_pk_bf16_f32 v80, v40, v41
  v_cvt_pk_bf16_f32 v81, v42, v43
  ds_write_b64 v12, v[80:81] offset:64
  v_cvt_pk_bf16_f32 v82, v44, v45
  v_cvt_pk_bf16_f32 v83, v46, v47
  ds_write_b64 v12, v[82:83] offset:80
  v_cvt_pk_bf16_f32 v84, v48, v49
  v_cvt_pk_bf16_f32 v85, v50, v51
  ds_write_b64 v12, v[84:85] offset:96
  v_cvt_pk_bf16_f32 v86, v52, v53
  v_cvt_pk_bf16_f32 v87, v54, v55
  ds_write_b64 v12, v[86:87] offset:112
  v_cvt_pk_bf16_f32 v88, v56, v57
  v_cvt_pk_bf16_f32 v89, v58, v59
  ds_write_b64 v12, v[88:89] offset:128
  s_lshl_b32 s29, s25, 7
  s_lshl_b32 s30, s3, 5
  s_add_u32 s29, s29, s30
  s_mul_i32 s29, s29, 2304
  s_mul_i32 s30, s24, 1152
  s_add_u32 s29, s29, s30
  s_mul_i32 s30, s34, 144
  s_add_u32 s29, s29, s30
  v_add_u32 v14, 0, v0
  v_mul_u32_u24 v15, 7282, v14
  v_lshrrev_b32 v15, 16, v15
  v_mul_u32_u24 v16, 9, v15
  v_sub_u32 v16, v14, v16
  v_lshlrev_b32 v16, 4, v16
  v_mul_u32_u24 v17, 176, v15
  v_add3_u32 v17, v17, v16, s28
  v_mul_u32_u24 v15, 2304, v15
  v_add_u32 v116, v15, v16
  ds_read_b128 v[96:99], v17
  v_add_u32 v14, 64, v0
  v_mul_u32_u24 v15, 7282, v14
  v_lshrrev_b32 v15, 16, v15
  v_mul_u32_u24 v16, 9, v15
  v_sub_u32 v16, v14, v16
  v_lshlrev_b32 v16, 4, v16
  v_mul_u32_u24 v17, 176, v15
  v_add3_u32 v17, v17, v16, s28
  v_mul_u32_u24 v15, 2304, v15
  v_add_u32 v117, v15, v16
  ds_read_b128 v[100:103], v17
  v_add_u32 v14, 128, v0
  v_mul_u32_u24 v15, 7282, v14
  v_lshrrev_b32 v15, 16, v15
  v_mul_u32_u24 v16, 9, v15
  v_sub_u32 v16, v14, v16
  v_lshlrev_b32 v16, 4, v16
  v_mul_u32_u24 v17, 176, v15
  v_add3_u32 v17, v17, v16, s28
  v_mul_u32_u24 v15, 2304, v15
  v_add_u32 v118, v15, v16
  ds_read_b128 v[104:107], v17
  v_add_u32 v14, 192, v0
  v_mul_u32_u24 v15, 7282, v14
  v_lshrrev_b32 v15, 16, v15
  v_mul_u32_u24 v16, 9, v15
  v_sub_u32 v16, v14, v16
  v_lshlrev_b32 v16, 4, v16
  v_mul_u32_u24 v17, 176, v15
  v_add3_u32 v17, v17, v16, s28
  v_mul_u32_u24 v15, 2304, v15
  v_add_u32 v119, v15, v16
  ds_read_b128 v[108:111], v17
  v_add_u32 v14, 256, v0
  v_mul_u32_u24 v15, 7282, v14
  v_lshrrev_b32 v15, 16, v15
  v_mul_u32_u24 v16, 9, v15
  v_sub_u32 v16, v14, v16
  v_lshlrev_b32 v16, 4, v16
  v_mul_u32_u24 v17, 176, v15
  v_add3_u32 v17, v17, v16, s28
  v_mul_u32_u24 v15, 2304, v15
  v_add_u32 v120, v15, v16
  v_bfe_u32 v14, v0, 5, 1
  v_lshlrev_b32 v14, 31, v14
  v_or_b32 v120, v120, v14
  ds_read_b128 v[112:115], v17
  s_waitcnt lgkmcnt(4)
  buffer_store_dwordx4 v[96:99], v116, s[16:19], s29 offen
  s_waitcnt lgkmcnt(3)
  buffer_store_dwordx4 v[100:103], v117, s[16:19], s29 offen
  s_waitcnt lgkmcnt(2)
  buffer_store_dwordx4 v[104:107], v118, s[16:19], s29 offen
  s_waitcnt lgkmcnt(1)
  buffer_store_dwordx4 v[108:111], v119, s[16:19], s29 offen
  s_waitcnt lgkmcnt(0)
  buffer_store_dwordx4 v[112:115], v120, s[16:19], s29 offen
L_END:
  s_endpgm
.section .rodata,"a"
.p2align 6
.amdhsa_kernel concat_heads__mha_block__linear_attn_block__prompt_kernel
  .amdhsa_next_free_vgpr 240
  .amdhsa_next_free_sgpr 102
  .amdhsa_accum_offset 240
  .amdhsa_group_segment_fixed_size 0
  .amdhsa_kernarg_size 72
  .amdhsa_user_sgpr_count 2
  .amdhsa_user_sgpr_kernarg_segment_ptr 1
  .amdhsa_system_sgpr_workgroup_id_x 1
.end_amdhsa_kernel
```
